```python
import torch

def _softmax(x, axis=-1):
    return torch.softmax(x, dim=axis)
def _gelu(x):
    return torch.nn.functional.gelu(x, approximate="tanh")
def _silu(x):
    return torch.nn.functional.silu(x)
def _sigmoid(x):
    return torch.sigmoid(x)
def _layernorm(x, axis=-1, eps=1e-5):
    m = x.mean(dim=axis, keepdim=True)
    v = x.var(dim=axis, keepdim=True, unbiased=False)
    return (x - m) / torch.sqrt(v + eps)
def _scatter_add(tgt, idx, src, axis=0):
    return tgt.clone().index_add_(axis, idx, src)
def _segment_sum(src, seg, n):
    out = torch.zeros((n,) + src.shape[1:], dtype=src.dtype)
    return out.index_add_(0, seg, src)
def _pad(x, pw):
    flat = tuple(v for pair in reversed(pw) for v in pair)
    return torch.nn.functional.pad(x, flat)

kernel_name = 'standalone__cross_network_dcn_v2__recsys'

def setup_inputs():

    _w = (lambda a: (lambda t: t.to(torch.bfloat16) if t.is_floating_point() else t)(torch.as_tensor(a)))
    B, F, D, L = 4096, 100, 16, 6
    Din = min(F * D, 512)
    R = max(Din // 4, 2)
    sc = Din ** -0.5
    return {
        "x0": _w((lambda *s: torch.randn(*s, dtype=torch.bfloat16) * 0.05)(B, Din)),
        "U":  _w((lambda *s: torch.randn(*s, dtype=torch.bfloat16) * 1.6)(L, Din, R) * sc),
        "V":  _w((lambda *s: torch.randn(*s, dtype=torch.bfloat16) * 1.6)(L, R, Din) * sc),
        "bs": _w((lambda *s: torch.randn(*s, dtype=torch.bfloat16) * 0.05)(L, Din)),
    }

def reference(x0, U, V, bs):
    x = x0
    for l in range(U.shape[0]):
        h = torch.einsum('rd,bd->br', V[l], x)
        h = torch.einsum('dr,br->bd', U[l], h)
        x = x0 * (h + bs[l]) + x
    return x
```

```asm
; @launch grid=(256,1,1) block=(512,1,1) lds=161792
.amdgcn_target "amdgcn-amd-amdhsa--gfx950"
.text
.globl standalone__cross_network_dcn_v2__recsys_kernel
.p2align 8
.type standalone__cross_network_dcn_v2__recsys_kernel,@function
standalone__cross_network_dcn_v2__recsys_kernel:
    s_load_dwordx8 s[36:43], s[0:1], 0
    s_load_dwordx4 s[44:47], s[0:1], 32
    s_load_dwordx2 s[48:49], s[0:1], 48
    s_cmp_ge_u32 s2, 256
    s_cbranch_scc1 L_end
    v_lshrrev_b32 v66, 6, v0
    v_and_b32 v1, 63, v0
    s_getpc_b64 s[4:5]
    v_lshlrev_b32_e64 v67, 7, v0
    s_and_b32 s4, s4, 0xffffff00
    v_cmp_gt_u32 vcc, CODE_BYTES, v67
    s_and_saveexec_b64 s[6:7], vcc
    s_cbranch_execz L_nocpf
    global_load_dword v0, v67, s[4:5]
L_nocpf:
    s_mov_b64 exec, -1
    v_readfirstlane_b32 s50, v66
    v_lshrrev_b32 v72, 3, v1
    v_and_b32 v68, 6, v72
    v_xor_b32 v68, v68, v1
    v_and_b32 v68, 7, v68
    v_lshlrev_b32 v68, 4, v68
    v_and_b32 v69, 4, v72
    v_add_u32_e64 v67, v72, v69
    v_lshl_add_u32 v69, v67, 10, v68
    v_add_u32 v4, 3072, v69
    v_add_u32 v5, 18432, v69
    s_and_b32 s71, s2, 0xf0
    s_lshl_b32 s71, s71, 14
    s_and_b32 s72, s2, 7
    s_lshl_b32 s72, s72, 15
    s_and_b32 s73, s2, 8
    s_lshl_b32 s73, s73, 6
    s_and_b32 s68, s50, 3
    s_lshr_b32 s69, s50, 2
    s_or_b32 s71, s71, s72
    s_lshl_b32 s72, s69, 12
    s_or_b32 s72, s72, s73
    s_or_b32 s75, s71, s72
    s_lshl_b32 s74, s68, 7
    s_add_u32 s78, s75, s74
    s_lshl1_add_u32 s76, s68, s69
    s_lshl_b32 s76, s76, 11
    s_add_u32 s76, s76, 131072
    s_lshr_b32 s71, s2, 3
    s_lshl3_add_u32 s71, s71, s50
    s_lshl_b32 s71, s71, 9
    s_lshl2_add_u32 s72, s2, s68
    s_lshl_b32 s72, s72, 7
    s_sub_u32 s72, s72, 393216
    v_lshl_add_u32 v74, v1, 7, s71
    v_lshl_add_u32 v75, v1, 17, s72
    v_cmp_gt_u32 vcc, 4, v1
    s_cmp_eq_u32 s69, 0
    s_cselect_b32 s71, 511, 15
    s_cselect_b32 s72, 15, 511
    v_cndmask_b32 v102, v75, v74, vcc
    s_waitcnt lgkmcnt(0)
    s_sub_u32 s4, s36, 3072
    s_subb_u32 s5, s37, 0
    s_mov_b32 s6, 4197376
    s_mov_b32 s7, 0x20000
    s_cmp_lg_u32 s69, 0
    s_cbranch_scc1 L_o1
    s_mov_b32 m0, s76
    s_nop 0
    buffer_load_dwordx4 v4, s[4:7], s78 offen lds
    buffer_load_dwordx4 v5, s[4:7], s78 offen offset:1024 lds
L_o1:
    s_sub_u32 s8, s40, 3072
    s_subb_u32 s9, s41, 0
    s_mov_b32 s10, 789504
    s_mov_b32 s11, 0x20000
    s_mov_b32 exec_hi, 0
    s_mov_b32 exec_lo, s71
    buffer_load_dword v0, v102, s[8:11], 0 offen offset:3072
    s_sub_u32 s12, s38, 3072
    s_subb_u32 s13, s39, 0
    s_mov_b32 s14, 789504
    s_mov_b32 s15, 0x20000
    s_mov_b32 exec_lo, s72
    buffer_load_dword v0, v102, s[12:15], 0 offen offset:3072
    s_mov_b64 exec, -1
    s_lshr_b32 s71, s68, 1
    s_lshl_b32 s71, s71, 13
    s_add_u32 s75, s75, s71
    s_and_b32 s77, s68, 1
    s_lshl_b32 s71, s77, 11
    s_add_u32 s66, s75, s71
    v_lshrrev_b32 v74, 5, v1
    v_and_b32 v3, 31, v1
    v_lshlrev_b32 v3, 4, v3
    v_lshl_add_u32 v3, v74, 10, v3
    v_mov_b32 v34, 0
    v_mov_b32 v35, 0
    v_mov_b32 v36, 0
    v_mov_b32 v37, 0
    s_mov_b32 s16, s44
    s_mov_b32 s17, s45
    s_mov_b32 s18, 4194304
    s_mov_b32 s19, 0x20000
    s_cmp_lg_u32 s69, 0
    s_cbranch_scc1 L_o2
    buffer_store_dwordx4 v[34:37], v3, s[16:19], s66 offen sc1
L_o2:
    v_and_b32 v73, 7, v1
    v_lshlrev_b32 v75, 4, v73
    v_lshl_add_u32 v75, v72, 10, v75
    s_mul_i32 s71, s69, 3072
    s_add_u32 s71, s71, s74
    s_add_u32 s71, s71, s73
    v_mov_b32 v24, s2
    v_xor_b32 v24, 8, v24
    s_mov_b32 s28, s42
    s_mov_b32 s29, s43
    s_mov_b32 s30, 6144
    s_mov_b32 s31, 0x20000
    s_mov_b32 s24, s46
    s_mov_b32 s25, s47
    s_mov_b32 s26, 256
    s_mov_b32 s27, 0x20000
    s_mov_b64 exec, 0xffffff
    buffer_load_dwordx4 v[38:41], v75, s[28:31], s71 offen
    s_mov_b64 exec, 1
    buffer_load_ubyte v0, v24, s[24:27], 0 offen
    s_mov_b64 exec, -1
    s_lshl_b32 s65, s68, 15
    s_add_u32 s71, s65, s73
    s_xor_b32 s75, s68, 0
    s_lshl_b32 s75, s75, 7
    s_add_u32 s55, s71, s75
    s_xor_b32 s75, s68, 1
    s_lshl_b32 s75, s75, 7
    s_add_u32 s56, s71, s75
    s_xor_b32 s75, s68, 2
    s_lshl_b32 s75, s75, 7
    s_add_u32 s57, s71, s75
    s_xor_b32 s75, s68, 3
    s_lshl_b32 s75, s75, 7
    s_add_u32 s58, s71, s75
    v_add_u32 v6, 5120, v69
    v_add_u32 v7, 20480, v69
    s_lshl_b32 s75, s69, 13
    s_add_u32 s75, s75, s65
    s_cmp_eq_u32 s69, 0
    s_cselect_b32 s71, s55, s57
    s_cselect_b32 s72, s56, s58
    s_add_u32 m0, s75, 0
    s_nop 0
    buffer_load_dwordx4 v4, s[8:11], s71 offen offset:0 lds
    buffer_load_dwordx4 v5, s[8:11], s71 offen offset:1024 lds
    buffer_load_dwordx4 v6, s[8:11], s71 offen offset:2048 lds
    buffer_load_dwordx4 v7, s[8:11], s71 offen offset:3072 lds
    s_add_u32 m0, s75, 4096
    s_nop 0
    buffer_load_dwordx4 v4, s[8:11], s72 offen offset:0 lds
    buffer_load_dwordx4 v5, s[8:11], s72 offen offset:1024 lds
    buffer_load_dwordx4 v6, s[8:11], s72 offen offset:2048 lds
    buffer_load_dwordx4 v7, s[8:11], s72 offen offset:3072 lds
    s_cmp_lg_u32 s69, 1
    s_cbranch_scc1 L_o3
    s_mov_b32 m0, s76
    s_nop 0
    buffer_load_dwordx4 v4, s[4:7], s78 offen lds
    buffer_load_dwordx4 v5, s[4:7], s78 offen offset:1024 lds
L_o3:
    s_add_u32 s67, s66, 16384
    s_mov_b32 s32, s48
    s_mov_b32 s33, s49
    s_mov_b32 s34, 8388608
    s_mov_b32 s35, 0x20000
    s_mov_b32 s20, s44
    s_mov_b32 s21, s45
    s_mov_b32 s22, 4194304
    s_mov_b32 s23, 0x20000
    s_getreg_b32 s53, hwreg(HW_REG_XCC_ID)
    s_and_b32 s53, s53, 15
    s_or_b32 s53, s53, 16
    v_lshl_add_u32 v70, v67, 8, v68
    s_lshl_b32 s71, s77, 6
    v_xor_b32_e64 v70, s71, v70
    v_add_u32 v8, 3072, v70
    v_add_u32 v9, 6144, v70
    v_add_u32 v10, 2048, v70
    v_add_u32 v11, 5120, v70
    s_lshl_b32 s71, s73, 7
    s_lshl_b32 s72, s68, 14
    s_add_u32 s71, s71, s72
    s_and_b32 s72, s68, 2
    s_lshl_b32 s72, s72, 6
    s_add_u32 s59, s71, s72
    s_add_u32 s60, s59, 8192
    s_xor_b32 s61, s59, 128
    s_xor_b32 s62, s60, 128
    v_lshrrev_b32 v66, 4, v1
    v_and_b32 v67, 6, v1
    v_xor_b32 v68, v67, v66
    v_lshlrev_b32 v68, 4, v68
    v_and_b32_e64 v67, 15, v1
    v_lshl_add_u32 v68, v67, 7, v68
    v_add_u32 v69, s76, v68
    v_xor_b32 v71, 64, v69
    v_add_u32 v2, s65, v68
    v_xor_b32 v21, 64, v2
    v_lshlrev_b32 v67, 4, v1
    v_add_u32 v12, s76, v67
    v_xor_b32 v13, 4096, v12
    v_xor_b32 v14, 8192, v12
    v_xor_b32 v15, 12288, v12
    s_lshl_b32 s71, s50, 10
    s_add_u32 s71, s71, 147456
    v_add_u32 v16, s71, v67
    v_xor_b32 v17, 1024, v16
    v_xor_b32 v18, 2048, v16
    v_xor_b32 v19, 3072, v16
    s_mul_i32 s71, s68, 1536
    s_add_u32 s71, s71, 155648
    v_lshl_add_u32 v20, v66, 5, s71
    s_mul_i32 s72, s69, 768
    s_add_u32 s71, s71, s72
    v_lshlrev_b32 v73, 5, v73
    v_lshl_add_u32 v73, v72, 8, v73
    v_add_u32 v22, s71, v73
    s_mov_b32 s5, s66
    s_mov_b32 s6, 51
    s_mov_b32 s7, 1
    s_cmp_lg_u32 s69, 0
    s_cbranch_scc1 L_progB
    s_waitcnt vmcnt(13)
    ds_read_b128 v[82:85], v69
    ds_read_b128 v[86:89], v71
    s_waitcnt lgkmcnt(0)
    ds_write_b128 v12, v[82:85] offset:0
    ds_write_b128 v12, v[86:89] offset:1024
    v_lshlrev_b32_e64 v66, 16, v82
    v_and_b32 v67, 0xffff0000, v82
    v_lshlrev_b32_e64 v68, 16, v83
    v_and_b32 v69, 0xffff0000, v83
    v_lshlrev_b32_e64 v70, 16, v84
    v_and_b32 v71, 0xffff0000, v84
    v_lshlrev_b32_e64 v72, 16, v85
    v_and_b32 v73, 0xffff0000, v85
    v_lshlrev_b32_e64 v74, 16, v86
    v_and_b32 v75, 0xffff0000, v86
    v_lshlrev_b32_e64 v76, 16, v87
    v_and_b32 v77, 0xffff0000, v87
    v_lshlrev_b32_e64 v78, 16, v88
    v_and_b32 v79, 0xffff0000, v88
    v_lshlrev_b32_e64 v80, 16, v89
    v_and_b32 v81, 0xffff0000, v89
    s_waitcnt vmcnt(9)
    v_lshlrev_b32 v42, 16, v38
    v_and_b32 v43, 0xffff0000, v38
    v_lshlrev_b32_e64 v44, 16, v39
    v_and_b32 v45, 0xffff0000, v39
    v_lshlrev_b32_e64 v46, 16, v40
    v_and_b32 v47, 0xffff0000, v40
    v_lshlrev_b32_e64 v48, 16, v41
    v_and_b32 v49, 0xffff0000, v41
    s_mov_b64 exec, 0xffffff
    ds_write_b128 v22, v[42:45]
    ds_write_b128 v22, v[46:49] offset:16
    s_mov_b64 exec, -1
    s_waitcnt vmcnt(0)
    s_waitcnt lgkmcnt(0)
    s_barrier
    s_setprio 2
    s_cmp_lg_u32 s50, 0
    s_cbranch_scc1 L_noflag0
    v_mov_b32 v98, s2
    v_mov_b32 v99, s53
    s_mov_b64 exec, 1
    buffer_store_byte v99, v98, s[24:27], 0 offen
    s_mov_b64 exec, -1
L_noflag0:
    ds_read_b128 a[0:3], v2 offset:0
    ds_read_b128 a[4:7], v2 offset:2048
    ds_read_b128 a[8:11], v21 offset:0
    ds_read_b128 a[12:15], v21 offset:2048
    ds_read_b128 a[128:131], v13 offset:0
    ds_read_b128 a[132:135], v13 offset:1024
    ds_read_b128 a[16:19], v2 offset:4096
    ds_read_b128 a[20:23], v2 offset:6144
    ds_read_b128 a[24:27], v21 offset:4096
    ds_read_b128 a[28:31], v21 offset:6144
    ds_read_b128 a[136:139], v14 offset:0
    ds_read_b128 a[140:143], v14 offset:1024
    s_waitcnt lgkmcnt(10)
    v_mfma_f32_16x16x32_bf16 v[26:29], a[0:3], v[82:85], 0
    ds_read_b128 a[32:35], v2 offset:8192
    v_mfma_f32_16x16x32_bf16 v[30:33], a[4:7], v[82:85], 0
    ds_read_b128 a[36:39], v2 offset:10240
    s_waitcnt lgkmcnt(10)
    v_mfma_f32_16x16x32_bf16 v[26:29], a[8:11], v[86:89], v[26:29]
    ds_read_b128 a[40:43], v21 offset:8192
    v_mfma_f32_16x16x32_bf16 v[30:33], a[12:15], v[86:89], v[30:33]
    ds_read_b128 a[44:47], v21 offset:10240
    s_waitcnt lgkmcnt(8)
    v_mfma_f32_16x16x32_bf16 v[26:29], a[16:19], a[128:131], v[26:29]
    ds_read_b128 a[144:147], v15 offset:0
    v_mfma_f32_16x16x32_bf16 v[30:33], a[20:23], a[128:131], v[30:33]
    ds_read_b128 a[148:151], v15 offset:1024
    s_waitcnt lgkmcnt(8)
    v_mfma_f32_16x16x32_bf16 v[26:29], a[24:27], a[132:135], v[26:29]
    ds_read_b128 a[48:51], v2 offset:12288
    v_mfma_f32_16x16x32_bf16 v[30:33], a[28:31], a[132:135], v[30:33]
    ds_read_b128 a[52:55], v2 offset:14336
    s_waitcnt lgkmcnt(6)
    v_mfma_f32_16x16x32_bf16 v[26:29], a[32:35], a[136:139], v[26:29]
    ds_read_b128 a[56:59], v21 offset:12288
    v_mfma_f32_16x16x32_bf16 v[30:33], a[36:39], a[136:139], v[30:33]
    ds_read_b128 a[60:63], v21 offset:14336
    s_waitcnt lgkmcnt(6)
    v_mfma_f32_16x16x32_bf16 v[26:29], a[40:43], a[140:143], v[26:29]
    v_mfma_f32_16x16x32_bf16 v[30:33], a[44:47], a[140:143], v[30:33]
    buffer_load_ubyte v23, v24, s[24:27], 0 offen sc1
    s_waitcnt lgkmcnt(2)
    v_mfma_f32_16x16x32_bf16 v[26:29], a[48:51], a[144:147], v[26:29]
    v_mfma_f32_16x16x32_bf16 v[30:33], a[52:55], a[144:147], v[30:33]
    s_waitcnt lgkmcnt(0)
    v_mfma_f32_16x16x32_bf16 v[26:29], a[56:59], a[148:151], v[26:29]
    v_mfma_f32_16x16x32_bf16 v[30:33], a[60:63], a[148:151], v[30:33]
    s_nop 6
    v_cvt_pk_bf16_f32 v90, v26, v27
    v_cvt_pk_bf16_f32 v91, v28, v29
    v_cvt_pk_bf16_f32 v92, v30, v31
    v_cvt_pk_bf16_f32 v93, v32, v33
    v_and_or_b32 v90, v90, -2, s7
    v_and_or_b32 v91, v91, -2, s7
    v_and_or_b32 v92, v92, -2, s7
    v_and_or_b32 v93, v93, -2, s7
    s_mov_b32 s70, 0
    s_mov_b32 s54, 1
    s_or_b32 s77, s53, 0
    s_waitcnt vmcnt(0)
    v_readfirstlane_b32 s71, v23
    s_and_b32 s71, s71, 31
    s_cmp_eq_u32 s71, s77
    s_cbranch_scc0 L_hs_fast0
L_hs_done0:
    s_xor_b32 s79, s5, 512
    s_cmp_eq_u32 s54, 0
    s_cbranch_scc1 L_ss00
    buffer_store_dwordx4 v[90:93], v3, s[20:23], s79 offen
L_sd00:
    v_lshlrev_b32_e64 v50, 16, v82
    v_and_b32 v51, 0xffff0000, v82
    v_lshlrev_b32_e64 v52, 16, v83
    v_and_b32 v53, 0xffff0000, v83
    v_lshlrev_b32_e64 v54, 16, v84
    v_and_b32 v55, 0xffff0000, v84
    v_lshlrev_b32_e64 v56, 16, v85
    v_and_b32 v57, 0xffff0000, v85
    v_lshlrev_b32_e64 v58, 16, v86
    v_and_b32 v59, 0xffff0000, v86
    v_lshlrev_b32_e64 v60, 16, v87
    v_and_b32 v61, 0xffff0000, v87
    v_lshlrev_b32_e64 v62, 16, v88
    v_and_b32 v63, 0xffff0000, v88
    v_lshlrev_b32_e64 v64, 16, v89
    v_and_b32 v65, 0xffff0000, v89
    s_setprio 0
    s_barrier
    s_cmp_lg_u32 s50, 0
    s_cbranch_scc1 L_noflag1
    v_mov_b32 v98, s2
    v_mov_b32 v99, s53
    v_or_b32 v99, 32, v99
    s_mov_b64 exec, 1
    buffer_store_byte v99, v98, s[24:27], 0 offen
    s_mov_b64 exec, -1
L_noflag1:
    s_add_u32 m0, s65, 0
    s_add_u32 s63, s55, 131072
    buffer_load_dwordx4 v4, s[8:11], s63 offen offset:0 lds
    buffer_load_dword v0, off, s[28:31], 0
    ds_read_b128 a[64:67], v2 offset:16384
    ds_read_b128 a[68:71], v2 offset:18432
    ds_read_b128 a[72:75], v21 offset:16384
    ds_read_b128 a[76:79], v21 offset:18432
    buffer_load_dwordx4 v5, s[8:11], s63 offen offset:1024 lds
    buffer_load_dword v0, off, s[28:31], 0
    ds_read_b128 a[80:83], v2 offset:20480
    ds_read_b128 a[84:87], v2 offset:22528
    ds_read_b128 a[88:91], v21 offset:20480
    ds_read_b128 a[92:95], v21 offset:22528
    buffer_load_dwordx4 v[94:97], v3, s[20:23], s5 offen sc1
    buffer_load_dwordx4 v6, s[8:11], s63 offen offset:2048 lds
    buffer_load_dword v0, off, s[28:31], 0
    ds_read_b128 v[34:37], v20 offset:0
    ds_read_b128 v[38:41], v20 offset:16
    ds_read_b128 v[42:45], v20 offset:128
    ds_read_b128 v[46:49], v20 offset:144
    buffer_load_dwordx4 v7, s[8:11], s63 offen offset:3072 lds
    buffer_load_dword v0, off, s[28:31], 0
    s_add_u32 m0, s65, 4096
    s_add_u32 s64, s56, 131072
    buffer_load_dwordx4 v4, s[8:11], s64 offen offset:0 lds
    buffer_load_dwordx4 v5, s[8:11], s64 offen offset:1024 lds
    buffer_load_dwordx4 v6, s[8:11], s64 offen offset:2048 lds
    buffer_load_dwordx4 v7, s[8:11], s64 offen offset:3072 lds
    s_waitcnt lgkmcnt(0)
    s_barrier
    ds_read_b128 a[96:99], v2 offset:24576
    ds_read_b128 a[100:103], v2 offset:26624
    ds_read_b128 a[104:107], v21 offset:24576
    ds_read_b128 a[108:111], v21 offset:26624
    s_waitcnt vmcnt(8)
    v_xor_b32 v25, s7, v94
    v_bitop3_b32 v25, v95, v25, s7 bitop3:0xde
    v_bitop3_b32 v25, v96, v25, s7 bitop3:0xde
    v_bitop3_b32 v25, v97, v25, s7 bitop3:0xde
    v_and_b32 v25, 1, v25
    v_cmp_ne_u32 vcc, 0, v25
    s_cbranch_vccnz L_rt00
L_got00:
    v_lshlrev_b32 v98, 16, v94
    v_and_b32 v99, 0xffff0000, v94
    v_lshlrev_b32_e64 v100, 16, v95
    v_and_b32 v101, 0xffff0000, v95
    v_add_f32 v98, v98, v26
    v_add_f32 v99, v99, v27
    v_add_f32 v100, v100, v28
    v_add_f32 v101, v101, v29
    v_cvt_pk_bf16_f32 v90, v98, v99
    v_cvt_pk_bf16_f32 v91, v100, v101
    v_lshlrev_b32_e64 v98, 16, v96
    v_and_b32 v99, 0xffff0000, v96
    v_lshlrev_b32_e64 v100, 16, v97
    v_and_b32 v101, 0xffff0000, v97
    v_add_f32 v98, v98, v30
    v_add_f32 v99, v99, v31
    v_add_f32 v100, v100, v32
    v_add_f32 v101, v101, v33
    v_cvt_pk_bf16_f32 v92, v98, v99
    v_cvt_pk_bf16_f32 v93, v100, v101
    ds_write_b128 v16, v[90:93]
    s_xor_b32 s5, s5, 16384
    s_lshr_b32 s6, s6, 1
    s_and_b32 s7, s6, 1
    ds_read_b128 a[112:115], v2 offset:28672
    ds_read_b128 a[116:119], v2 offset:30720
    ds_read_b128 a[120:123], v21 offset:28672
    ds_read_b128 a[124:127], v21 offset:30720
    s_waitcnt vmcnt(0)
    s_waitcnt lgkmcnt(0)
    s_barrier
    s_mov_b32 s4, 262144
    v_add_u32 v20, 256, v20
    s_mov_b32 s3, 4
    .p2align 6
L_loop0:
    s_setprio 2
    ds_read_b128 a[128:131], v17
    ds_read_b128 a[132:135], v18
    ds_read_b128 a[136:139], v19
    v_mfma_f32_16x16x32_bf16 v[34:37], a[64:67], v[90:93], v[34:37]
    ds_read_b128 a[0:3], v2 offset:0
    v_mfma_f32_16x16x32_bf16 v[38:41], a[68:71], v[90:93], v[38:41]
    ds_read_b128 a[4:7], v2 offset:2048
    v_mfma_f32_16x16x32_bf16 v[42:45], a[80:83], v[90:93], v[42:45]
    ds_read_b128 a[8:11], v21 offset:0
    v_mfma_f32_16x16x32_bf16 v[46:49], a[84:87], v[90:93], v[46:49]
    ds_read_b128 a[12:15], v21 offset:2048
    s_waitcnt lgkmcnt(6)
    v_mfma_f32_16x16x32_bf16 v[34:37], a[72:75], a[128:131], v[34:37]
    ds_read_b128 a[16:19], v2 offset:4096
    v_mfma_f32_16x16x32_bf16 v[38:41], a[76:79], a[128:131], v[38:41]
    ds_read_b128 a[20:23], v2 offset:6144
    s_waitcnt lgkmcnt(7)
    v_mfma_f32_16x16x32_bf16 v[34:37], a[96:99], a[132:135], v[34:37]
    ds_read_b128 a[24:27], v21 offset:4096
    v_mfma_f32_16x16x32_bf16 v[38:41], a[100:103], a[132:135], v[38:41]
    ds_read_b128 a[28:31], v21 offset:6144
    s_waitcnt lgkmcnt(8)
    v_mfma_f32_16x16x32_bf16 v[34:37], a[104:107], a[136:139], v[34:37]
    v_mfma_f32_16x16x32_bf16 v[38:41], a[108:111], a[136:139], v[38:41]
    v_mfma_f32_16x16x32_bf16 v[42:45], a[88:91], a[128:131], v[42:45]
    v_mfma_f32_16x16x32_bf16 v[46:49], a[92:95], a[128:131], v[46:49]
    v_mfma_f32_16x16x32_bf16 v[42:45], a[112:115], a[132:135], v[42:45]
    v_mfma_f32_16x16x32_bf16 v[46:49], a[116:119], a[132:135], v[46:49]
    v_mfma_f32_16x16x32_bf16 v[42:45], a[120:123], a[136:139], v[42:45]
    s_nop 1
    v_fma_f32 v34, v66, v34, v50
    v_fma_f32 v35, v67, v35, v51
    v_mfma_f32_16x16x32_bf16 v[46:49], a[124:127], a[136:139], v[46:49]
    v_fma_f32 v36, v68, v36, v52
    v_fma_f32 v37, v69, v37, v53
    v_fma_f32 v38, v70, v38, v54
    v_fma_f32 v39, v71, v39, v55
    v_fma_f32 v40, v72, v40, v56
    v_fma_f32 v41, v73, v41, v57
    v_cvt_pk_bf16_f32 v82, v34, v35
    v_cvt_pk_bf16_f32 v83, v36, v37
    v_cvt_pk_bf16_f32 v84, v38, v39
    v_cvt_pk_bf16_f32 v85, v40, v41
    ds_write_b128 v12, v[82:85] offset:0
    v_pk_fma_f32 v[42:43], v[74:75], v[42:43], v[58:59]
    v_pk_fma_f32 v[44:45], v[76:77], v[44:45], v[60:61]
    v_pk_fma_f32 v[46:47], v[78:79], v[46:47], v[62:63]
    v_pk_fma_f32 v[48:49], v[80:81], v[48:49], v[64:65]
    v_cvt_pk_bf16_f32 v86, v42, v43
    v_cvt_pk_bf16_f32 v87, v44, v45
    v_cvt_pk_bf16_f32 v88, v46, v47
    v_cvt_pk_bf16_f32 v89, v48, v49
    ds_write_b128 v12, v[86:89] offset:1024
    s_waitcnt vmcnt(1)
    s_waitcnt lgkmcnt(0)
    s_barrier
    ds_read_b128 a[128:131], v13 offset:0
    ds_read_b128 a[132:135], v13 offset:1024
    v_mfma_f32_16x16x32_bf16 v[26:29], a[0:3], v[82:85], 0
    ds_read_b128 a[136:139], v14 offset:0
    ds_read_b128 a[32:35], v2 offset:8192
    v_mfma_f32_16x16x32_bf16 v[30:33], a[4:7], v[82:85], 0
    ds_read_b128 a[36:39], v2 offset:10240
    v_mfma_f32_16x16x32_bf16 v[26:29], a[8:11], v[86:89], v[26:29]
    ds_read_b128 a[140:143], v14 offset:1024
    ds_read_b128 a[40:43], v21 offset:8192
    v_mfma_f32_16x16x32_bf16 v[30:33], a[12:15], v[86:89], v[30:33]
    ds_read_b128 a[44:47], v21 offset:10240
    s_waitcnt lgkmcnt(7)
    v_mfma_f32_16x16x32_bf16 v[26:29], a[16:19], a[128:131], v[26:29]
    ds_read_b128 a[144:147], v15 offset:0
    ds_read_b128 a[48:51], v2 offset:12288
    v_mfma_f32_16x16x32_bf16 v[30:33], a[20:23], a[128:131], v[30:33]
    ds_read_b128 a[52:55], v2 offset:14336
    s_waitcnt lgkmcnt(9)
    v_mfma_f32_16x16x32_bf16 v[26:29], a[24:27], a[132:135], v[26:29]
    ds_read_b128 a[148:151], v15 offset:1024
    ds_read_b128 a[56:59], v21 offset:12288
    v_mfma_f32_16x16x32_bf16 v[30:33], a[28:31], a[132:135], v[30:33]
    ds_read_b128 a[60:63], v21 offset:14336
    s_waitcnt lgkmcnt(9)
    v_mfma_f32_16x16x32_bf16 v[26:29], a[32:35], a[136:139], v[26:29]
    v_mfma_f32_16x16x32_bf16 v[30:33], a[36:39], a[136:139], v[30:33]
    s_waitcnt lgkmcnt(6)
    v_mfma_f32_16x16x32_bf16 v[26:29], a[40:43], a[140:143], v[26:29]
    v_mfma_f32_16x16x32_bf16 v[30:33], a[44:47], a[140:143], v[30:33]
    s_waitcnt lgkmcnt(3)
    v_mfma_f32_16x16x32_bf16 v[26:29], a[48:51], a[144:147], v[26:29]
    v_mfma_f32_16x16x32_bf16 v[30:33], a[52:55], a[144:147], v[30:33]
    s_waitcnt lgkmcnt(0)
    v_mfma_f32_16x16x32_bf16 v[26:29], a[56:59], a[148:151], v[26:29]
    v_mfma_f32_16x16x32_bf16 v[30:33], a[60:63], a[148:151], v[30:33]
    s_nop 6
    v_cvt_pk_bf16_f32 v90, v26, v27
    v_cvt_pk_bf16_f32 v91, v28, v29
    v_cvt_pk_bf16_f32 v92, v30, v31
    v_cvt_pk_bf16_f32 v93, v32, v33
    v_and_or_b32 v90, v90, -2, s7
    v_and_or_b32 v91, v91, -2, s7
    v_and_or_b32 v92, v92, -2, s7
    v_and_or_b32 v93, v93, -2, s7
    s_xor_b32 s79, s5, 512
    s_cmp_eq_u32 s54, 0
    s_cbranch_scc1 L_ss02
    buffer_store_dwordx4 v[90:93], v3, s[20:23], s79 offen
L_sd02:
    v_lshlrev_b32 v50, 16, v82
    v_and_b32 v51, 0xffff0000, v82
    v_lshlrev_b32_e64 v52, 16, v83
    v_and_b32 v53, 0xffff0000, v83
    v_lshlrev_b32_e64 v54, 16, v84
    v_and_b32 v55, 0xffff0000, v84
    v_lshlrev_b32_e64 v56, 16, v85
    v_and_b32 v57, 0xffff0000, v85
    v_lshlrev_b32_e64 v58, 16, v86
    v_and_b32 v59, 0xffff0000, v86
    v_lshlrev_b32_e64 v60, 16, v87
    v_and_b32 v61, 0xffff0000, v87
    v_lshlrev_b32_e64 v62, 16, v88
    v_and_b32 v63, 0xffff0000, v88
    v_lshlrev_b32_e64 v64, 16, v89
    v_and_b32 v65, 0xffff0000, v89
    s_setprio 0
    s_barrier
    s_add_u32 m0, s65, 0
    s_add_u32 s63, s55, s4
    buffer_load_dwordx4 v4, s[8:11], s63 offen offset:0 lds
    buffer_load_dword v0, off, s[28:31], 0
    ds_read_b128 a[64:67], v2 offset:16384
    ds_read_b128 a[68:71], v2 offset:18432
    ds_read_b128 a[72:75], v21 offset:16384
    ds_read_b128 a[76:79], v21 offset:18432
    buffer_load_dwordx4 v5, s[8:11], s63 offen offset:1024 lds
    buffer_load_dword v0, off, s[28:31], 0
    ds_read_b128 a[80:83], v2 offset:20480
    ds_read_b128 a[84:87], v2 offset:22528
    ds_read_b128 a[88:91], v21 offset:20480
    ds_read_b128 a[92:95], v21 offset:22528
    buffer_load_dwordx4 v[94:97], v3, s[20:23], s5 offen sc1
    buffer_load_dwordx4 v6, s[8:11], s63 offen offset:2048 lds
    buffer_load_dword v0, off, s[28:31], 0
    ds_read_b128 v[34:37], v20 offset:0
    ds_read_b128 v[38:41], v20 offset:16
    ds_read_b128 v[42:45], v20 offset:128
    ds_read_b128 v[46:49], v20 offset:144
    buffer_load_dwordx4 v7, s[8:11], s63 offen offset:3072 lds
    buffer_load_dword v0, off, s[28:31], 0
    s_add_u32 m0, s65, 4096
    s_add_u32 s64, s56, s4
    buffer_load_dwordx4 v4, s[8:11], s64 offen offset:0 lds
    buffer_load_dwordx4 v5, s[8:11], s64 offen offset:1024 lds
    buffer_load_dwordx4 v6, s[8:11], s64 offen offset:2048 lds
    buffer_load_dwordx4 v7, s[8:11], s64 offen offset:3072 lds
    s_waitcnt lgkmcnt(0)
    s_barrier
    s_add_u32 m0, s65, 8192
    s_add_u32 s63, s57, s4
    buffer_load_dwordx4 v4, s[8:11], s63 offen offset:0 lds
    buffer_load_dwordx4 v5, s[8:11], s63 offen offset:1024 lds
    buffer_load_dwordx4 v6, s[8:11], s63 offen offset:2048 lds
    ds_read_b128 a[96:99], v2 offset:24576
    ds_read_b128 a[100:103], v2 offset:26624
    ds_read_b128 a[104:107], v21 offset:24576
    ds_read_b128 a[108:111], v21 offset:26624
    buffer_load_dwordx4 v7, s[8:11], s63 offen offset:3072 lds
    ds_read_b128 a[112:115], v2 offset:28672
    ds_read_b128 a[116:119], v2 offset:30720
    ds_read_b128 a[120:123], v21 offset:28672
    ds_read_b128 a[124:127], v21 offset:30720
    s_add_u32 m0, s65, 12288
    s_add_u32 s64, s58, s4
    buffer_load_dwordx4 v4, s[8:11], s64 offen offset:0 lds
    s_waitcnt vmcnt(13)
    v_xor_b32_e64 v25, s7, v94
    v_bitop3_b32 v25, v95, v25, s7 bitop3:0xde
    v_bitop3_b32 v25, v96, v25, s7 bitop3:0xde
    v_bitop3_b32 v25, v97, v25, s7 bitop3:0xde
    v_and_b32 v25, 1, v25
    v_cmp_ne_u32 vcc, 0, v25
    s_cbranch_vccnz L_rt02
L_got02:
    v_lshlrev_b32 v98, 16, v94
    v_and_b32 v99, 0xffff0000, v94
    v_lshlrev_b32_e64 v100, 16, v95
    v_and_b32 v101, 0xffff0000, v95
    v_add_f32 v98, v98, v26
    v_add_f32 v99, v99, v27
    v_add_f32 v100, v100, v28
    v_add_f32 v101, v101, v29
    v_cvt_pk_bf16_f32 v90, v98, v99
    v_cvt_pk_bf16_f32 v91, v100, v101
    buffer_load_dwordx4 v5, s[8:11], s64 offen offset:1024 lds
    v_lshlrev_b32_e64 v98, 16, v96
    v_and_b32 v99, 0xffff0000, v96
    v_lshlrev_b32_e64 v100, 16, v97
    v_and_b32 v101, 0xffff0000, v97
    v_add_f32 v98, v98, v30
    v_add_f32 v99, v99, v31
    v_add_f32 v100, v100, v32
    v_add_f32 v101, v101, v33
    v_cvt_pk_bf16_f32 v92, v98, v99
    v_cvt_pk_bf16_f32 v93, v100, v101
    ds_write_b128 v16, v[90:93]
    s_xor_b32 s5, s5, 16384
    s_lshr_b32 s6, s6, 1
    s_and_b32 s7, s6, 1
    s_waitcnt vmcnt(6)
    buffer_load_dwordx4 v6, s[8:11], s64 offen offset:2048 lds
    buffer_load_dwordx4 v7, s[8:11], s64 offen offset:3072 lds
    buffer_load_dword v0, off, s[28:31], 0
    s_waitcnt lgkmcnt(0)
    s_add_u32 s4, s4, 131072
    v_add_u32 v20, 256, v20
    s_sub_u32 s3, s3, 1
    s_cmp_lg_u32 s3, 0
    s_barrier
    s_cbranch_scc1 L_loop0
    s_setprio 2
    ds_read_b128 a[128:131], v17
    ds_read_b128 a[132:135], v18
    ds_read_b128 a[136:139], v19
    v_mfma_f32_16x16x32_bf16 v[34:37], a[64:67], v[90:93], v[34:37]
    ds_read_b128 a[0:3], v2 offset:0
    v_mfma_f32_16x16x32_bf16 v[38:41], a[68:71], v[90:93], v[38:41]
    ds_read_b128 a[4:7], v2 offset:2048
    v_mfma_f32_16x16x32_bf16 v[42:45], a[80:83], v[90:93], v[42:45]
    ds_read_b128 a[8:11], v21 offset:0
    v_mfma_f32_16x16x32_bf16 v[46:49], a[84:87], v[90:93], v[46:49]
    ds_read_b128 a[12:15], v21 offset:2048
    s_waitcnt lgkmcnt(6)
    v_mfma_f32_16x16x32_bf16 v[34:37], a[72:75], a[128:131], v[34:37]
    ds_read_b128 a[16:19], v2 offset:4096
    v_mfma_f32_16x16x32_bf16 v[38:41], a[76:79], a[128:131], v[38:41]
    ds_read_b128 a[20:23], v2 offset:6144
    s_waitcnt lgkmcnt(7)
    v_mfma_f32_16x16x32_bf16 v[34:37], a[96:99], a[132:135], v[34:37]
    ds_read_b128 a[24:27], v21 offset:4096
    v_mfma_f32_16x16x32_bf16 v[38:41], a[100:103], a[132:135], v[38:41]
    ds_read_b128 a[28:31], v21 offset:6144
    s_waitcnt lgkmcnt(8)
    v_mfma_f32_16x16x32_bf16 v[34:37], a[104:107], a[136:139], v[34:37]
    v_mfma_f32_16x16x32_bf16 v[38:41], a[108:111], a[136:139], v[38:41]
    v_mfma_f32_16x16x32_bf16 v[42:45], a[88:91], a[128:131], v[42:45]
    v_mfma_f32_16x16x32_bf16 v[46:49], a[92:95], a[128:131], v[46:49]
    v_mfma_f32_16x16x32_bf16 v[42:45], a[112:115], a[132:135], v[42:45]
    v_mfma_f32_16x16x32_bf16 v[46:49], a[116:119], a[132:135], v[46:49]
    v_mfma_f32_16x16x32_bf16 v[42:45], a[120:123], a[136:139], v[42:45]
    s_nop 1
    v_fma_f32 v34, v66, v34, v50
    v_fma_f32 v35, v67, v35, v51
    v_mfma_f32_16x16x32_bf16 v[46:49], a[124:127], a[136:139], v[46:49]
    v_fma_f32 v36, v68, v36, v52
    v_fma_f32 v37, v69, v37, v53
    v_fma_f32 v38, v70, v38, v54
    v_fma_f32 v39, v71, v39, v55
    v_fma_f32 v40, v72, v40, v56
    v_fma_f32 v41, v73, v41, v57
    v_cvt_pk_bf16_f32 v82, v34, v35
    v_cvt_pk_bf16_f32 v83, v36, v37
    v_cvt_pk_bf16_f32 v84, v38, v39
    v_cvt_pk_bf16_f32 v85, v40, v41
    ds_write_b128 v12, v[82:85] offset:0
    v_pk_fma_f32 v[42:43], v[74:75], v[42:43], v[58:59]
    v_pk_fma_f32 v[44:45], v[76:77], v[44:45], v[60:61]
    v_pk_fma_f32 v[46:47], v[78:79], v[46:47], v[62:63]
    v_pk_fma_f32 v[48:49], v[80:81], v[48:49], v[64:65]
    v_cvt_pk_bf16_f32 v86, v42, v43
    v_cvt_pk_bf16_f32 v87, v44, v45
    v_cvt_pk_bf16_f32 v88, v46, v47
    v_cvt_pk_bf16_f32 v89, v48, v49
    ds_write_b128 v12, v[86:89] offset:1024
    s_waitcnt vmcnt(1)
    s_waitcnt lgkmcnt(0)
    s_barrier
    ds_read_b128 a[128:131], v13 offset:0
    ds_read_b128 a[132:135], v13 offset:1024
    v_mfma_f32_16x16x32_bf16 v[26:29], a[0:3], v[82:85], 0
    ds_read_b128 a[136:139], v14 offset:0
    ds_read_b128 a[32:35], v2 offset:8192
    v_mfma_f32_16x16x32_bf16 v[30:33], a[4:7], v[82:85], 0
    ds_read_b128 a[36:39], v2 offset:10240
    v_mfma_f32_16x16x32_bf16 v[26:29], a[8:11], v[86:89], v[26:29]
    ds_read_b128 a[140:143], v14 offset:1024
    ds_read_b128 a[40:43], v21 offset:8192
    v_mfma_f32_16x16x32_bf16 v[30:33], a[12:15], v[86:89], v[30:33]
    ds_read_b128 a[44:47], v21 offset:10240
    s_waitcnt lgkmcnt(7)
    v_mfma_f32_16x16x32_bf16 v[26:29], a[16:19], a[128:131], v[26:29]
    ds_read_b128 a[144:147], v15 offset:0
    ds_read_b128 a[48:51], v2 offset:12288
    v_mfma_f32_16x16x32_bf16 v[30:33], a[20:23], a[128:131], v[30:33]
    ds_read_b128 a[52:55], v2 offset:14336
    s_waitcnt lgkmcnt(9)
    v_mfma_f32_16x16x32_bf16 v[26:29], a[24:27], a[132:135], v[26:29]
    ds_read_b128 a[148:151], v15 offset:1024
    ds_read_b128 a[56:59], v21 offset:12288
    v_mfma_f32_16x16x32_bf16 v[30:33], a[28:31], a[132:135], v[30:33]
    ds_read_b128 a[60:63], v21 offset:14336
    s_waitcnt lgkmcnt(9)
    v_mfma_f32_16x16x32_bf16 v[26:29], a[32:35], a[136:139], v[26:29]
    v_mfma_f32_16x16x32_bf16 v[30:33], a[36:39], a[136:139], v[30:33]
    s_waitcnt lgkmcnt(6)
    v_mfma_f32_16x16x32_bf16 v[26:29], a[40:43], a[140:143], v[26:29]
    v_mfma_f32_16x16x32_bf16 v[30:33], a[44:47], a[140:143], v[30:33]
    s_waitcnt lgkmcnt(3)
    v_mfma_f32_16x16x32_bf16 v[26:29], a[48:51], a[144:147], v[26:29]
    v_mfma_f32_16x16x32_bf16 v[30:33], a[52:55], a[144:147], v[30:33]
    s_waitcnt lgkmcnt(0)
    v_mfma_f32_16x16x32_bf16 v[26:29], a[56:59], a[148:151], v[26:29]
    v_mfma_f32_16x16x32_bf16 v[30:33], a[60:63], a[148:151], v[30:33]
    s_nop 6
    v_cvt_pk_bf16_f32 v90, v26, v27
    v_cvt_pk_bf16_f32 v91, v28, v29
    v_cvt_pk_bf16_f32 v92, v30, v31
    v_cvt_pk_bf16_f32 v93, v32, v33
    v_and_or_b32 v90, v90, -2, s7
    v_and_or_b32 v91, v91, -2, s7
    v_and_or_b32 v92, v92, -2, s7
    v_and_or_b32 v93, v93, -2, s7
    s_xor_b32 s79, s5, 512
    s_cmp_eq_u32 s54, 0
    s_cbranch_scc1 L_ss05
    buffer_store_dwordx4 v[90:93], v3, s[20:23], s79 offen
L_sd05:
    v_lshlrev_b32 v50, 16, v82
    v_and_b32 v51, 0xffff0000, v82
    v_lshlrev_b32_e64 v52, 16, v83
    v_and_b32 v53, 0xffff0000, v83
    v_lshlrev_b32_e64 v54, 16, v84
    v_and_b32 v55, 0xffff0000, v84
    v_lshlrev_b32_e64 v56, 16, v85
    v_and_b32 v57, 0xffff0000, v85
    v_lshlrev_b32_e64 v58, 16, v86
    v_and_b32 v59, 0xffff0000, v86
    v_lshlrev_b32_e64 v60, 16, v87
    v_and_b32 v61, 0xffff0000, v87
    v_lshlrev_b32_e64 v62, 16, v88
    v_and_b32 v63, 0xffff0000, v88
    v_lshlrev_b32_e64 v64, 16, v89
    v_and_b32 v65, 0xffff0000, v89
    s_setprio 0
    s_barrier
    ds_read_b128 a[64:67], v2 offset:16384
    ds_read_b128 a[68:71], v2 offset:18432
    ds_read_b128 a[72:75], v21 offset:16384
    ds_read_b128 a[76:79], v21 offset:18432
    ds_read_b128 a[80:83], v2 offset:20480
    ds_read_b128 a[84:87], v2 offset:22528
    ds_read_b128 a[88:91], v21 offset:20480
    ds_read_b128 a[92:95], v21 offset:22528
    buffer_load_dwordx4 v[94:97], v3, s[20:23], s5 offen sc1
    ds_read_b128 v[34:37], v20 offset:0
    ds_read_b128 v[38:41], v20 offset:16
    ds_read_b128 v[42:45], v20 offset:128
    ds_read_b128 v[46:49], v20 offset:144
    s_waitcnt lgkmcnt(0)
    s_barrier
    s_waitcnt vmcnt(0)
    v_xor_b32 v25, s7, v94
    v_bitop3_b32 v25, v95, v25, s7 bitop3:0xde
    v_bitop3_b32 v25, v96, v25, s7 bitop3:0xde
    v_bitop3_b32 v25, v97, v25, s7 bitop3:0xde
    v_and_b32 v25, 1, v25
    v_cmp_ne_u32 vcc, 0, v25
    s_cbranch_vccnz L_rt05
L_got05:
    v_lshlrev_b32 v98, 16, v94
    v_and_b32 v99, 0xffff0000, v94
    v_lshlrev_b32_e64 v100, 16, v95
    v_and_b32 v101, 0xffff0000, v95
    v_add_f32 v98, v98, v26
    v_add_f32 v99, v99, v27
    v_add_f32 v100, v100, v28
    v_add_f32 v101, v101, v29
    v_cvt_pk_bf16_f32 v90, v98, v99
    v_cvt_pk_bf16_f32 v91, v100, v101
    v_lshlrev_b32_e64 v98, 16, v96
    v_and_b32 v99, 0xffff0000, v96
    v_lshlrev_b32_e64 v100, 16, v97
    v_and_b32 v101, 0xffff0000, v97
    v_add_f32 v98, v98, v30
    v_add_f32 v99, v99, v31
    v_add_f32 v100, v100, v32
    v_add_f32 v101, v101, v33
    v_cvt_pk_bf16_f32 v92, v98, v99
    v_cvt_pk_bf16_f32 v93, v100, v101
    ds_write_b128 v16, v[90:93]
    s_xor_b32 s5, s5, 16384
    s_lshr_b32 s6, s6, 1
    s_and_b32 s7, s6, 1
    ds_read_b128 a[96:99], v2 offset:24576
    ds_read_b128 a[100:103], v2 offset:26624
    ds_read_b128 a[104:107], v21 offset:24576
    ds_read_b128 a[108:111], v21 offset:26624
    ds_read_b128 a[112:115], v2 offset:28672
    ds_read_b128 a[116:119], v2 offset:30720
    ds_read_b128 a[120:123], v21 offset:28672
    ds_read_b128 a[124:127], v21 offset:30720
    v_and_b32 v94, 15, v1
    v_lshrrev_b32 v95, 4, v1
    v_and_b32 v96, 7, v94
    v_xor_b32 v96, v96, v95
    v_lshlrev_b32_e64 v96, 4, v96
    v_lshl_add_u32 v96, v94, 7, v96
    v_and_b32 v22, 0xfffff800, v12
    v_add_u32 v22, v22, v96
    v_xor_b32 v23, 64, v22
    v_lshrrev_b32 v94, 3, v1
    v_xor_b32 v95, v94, v1
    v_and_b32 v95, 7, v95
    v_lshlrev_b32 v95, 4, v95
    v_and_b32 v96, 4, v94
    v_add_u32 v94, v94, v96
    v_lshl_add_u32 v24, v94, 10, v95
    s_waitcnt lgkmcnt(0)
    s_add_u32 s4, s4, 131072
    v_add_u32 v20, 256, v20
    s_barrier
    s_setprio 2
    ds_read_b128 a[128:131], v17
    ds_read_b128 a[132:135], v18
    ds_read_b128 a[136:139], v19
    v_mfma_f32_16x16x32_bf16 v[34:37], a[64:67], v[90:93], v[34:37]
    v_mfma_f32_16x16x32_bf16 v[38:41], a[68:71], v[90:93], v[38:41]
    v_mfma_f32_16x16x32_bf16 v[42:45], a[80:83], v[90:93], v[42:45]
    v_mfma_f32_16x16x32_bf16 v[46:49], a[84:87], v[90:93], v[46:49]
    s_waitcnt lgkmcnt(2)
    v_mfma_f32_16x16x32_bf16 v[34:37], a[72:75], a[128:131], v[34:37]
    v_mfma_f32_16x16x32_bf16 v[38:41], a[76:79], a[128:131], v[38:41]
    s_waitcnt lgkmcnt(1)
    v_mfma_f32_16x16x32_bf16 v[34:37], a[96:99], a[132:135], v[34:37]
    v_mfma_f32_16x16x32_bf16 v[38:41], a[100:103], a[132:135], v[38:41]
    s_waitcnt lgkmcnt(0)
    v_mfma_f32_16x16x32_bf16 v[34:37], a[104:107], a[136:139], v[34:37]
    v_mfma_f32_16x16x32_bf16 v[38:41], a[108:111], a[136:139], v[38:41]
    v_mfma_f32_16x16x32_bf16 v[42:45], a[88:91], a[128:131], v[42:45]
    v_mfma_f32_16x16x32_bf16 v[46:49], a[92:95], a[128:131], v[46:49]
    v_mfma_f32_16x16x32_bf16 v[42:45], a[112:115], a[132:135], v[42:45]
    v_mfma_f32_16x16x32_bf16 v[46:49], a[116:119], a[132:135], v[46:49]
    v_mfma_f32_16x16x32_bf16 v[42:45], a[120:123], a[136:139], v[42:45]
    s_nop 1
    v_fma_f32 v34, v66, v34, v50
    v_fma_f32 v35, v67, v35, v51
    v_mfma_f32_16x16x32_bf16 v[46:49], a[124:127], a[136:139], v[46:49]
    v_fma_f32 v36, v68, v36, v52
    v_fma_f32 v37, v69, v37, v53
    v_fma_f32 v38, v70, v38, v54
    v_fma_f32 v39, v71, v39, v55
    v_fma_f32 v40, v72, v40, v56
    v_fma_f32 v41, v73, v41, v57
    v_cvt_pk_bf16_f32 v82, v34, v35
    v_cvt_pk_bf16_f32 v83, v36, v37
    v_cvt_pk_bf16_f32 v84, v38, v39
    v_cvt_pk_bf16_f32 v85, v40, v41
    ds_write_b128 v22, v[82:85]
    v_pk_fma_f32 v[42:43], v[74:75], v[42:43], v[58:59]
    v_pk_fma_f32 v[44:45], v[76:77], v[44:45], v[60:61]
    v_pk_fma_f32 v[46:47], v[78:79], v[46:47], v[62:63]
    v_pk_fma_f32 v[48:49], v[80:81], v[48:49], v[64:65]
    v_cvt_pk_bf16_f32 v86, v42, v43
    v_cvt_pk_bf16_f32 v87, v44, v45
    v_cvt_pk_bf16_f32 v88, v46, v47
    v_cvt_pk_bf16_f32 v89, v48, v49
    ds_write_b128 v23, v[86:89]
    ds_read_b128 v[50:53], v12 offset:0
    ds_read_b128 v[54:57], v12 offset:1024
    s_add_u32 s71, s78, 0
    s_waitcnt lgkmcnt(1)
    buffer_store_dwordx4 v[50:53], v24, s[16:19], s71 offen
    s_add_u32 s72, s78, 16384
    s_waitcnt lgkmcnt(0)
    buffer_store_dwordx4 v[54:57], v24, s[16:19], s72 offen
    s_barrier
    s_endpgm
L_progB:
    s_add_u32 m0, s65, 16384
    s_add_u32 s63, s59, 0
    buffer_load_dwordx4 v8, s[12:15], s63 offen offset:0 lds
    buffer_load_dwordx4 v9, s[12:15], s63 offen offset:1024 lds
    buffer_load_dwordx4 v10, s[12:15], s63 offen offset:2048 lds
    buffer_load_dwordx4 v11, s[12:15], s63 offen offset:3072 lds
    s_waitcnt vmcnt(6)
    s_barrier
    ds_read_b128 a[0:3], v2 offset:0
    ds_read_b128 a[4:7], v2 offset:2048
    ds_read_b128 a[8:11], v21 offset:0
    ds_read_b128 a[12:15], v21 offset:2048
    ds_read_b128 a[16:19], v2 offset:4096
    ds_read_b128 a[20:23], v2 offset:6144
    ds_read_b128 a[24:27], v21 offset:4096
    ds_read_b128 a[28:31], v21 offset:6144
    s_add_u32 m0, s65, 20480
    s_add_u32 s64, s60, 0
    buffer_load_dwordx4 v8, s[12:15], s64 offen offset:0 lds
    buffer_load_dwordx4 v9, s[12:15], s64 offen offset:1024 lds
    buffer_load_dwordx4 v10, s[12:15], s64 offen offset:2048 lds
    buffer_load_dwordx4 v11, s[12:15], s64 offen offset:3072 lds
    ds_read_b128 a[32:35], v2 offset:8192
    ds_read_b128 a[36:39], v2 offset:10240
    ds_read_b128 a[40:43], v21 offset:8192
    ds_read_b128 a[44:47], v21 offset:10240
    ds_read_b128 a[48:51], v2 offset:12288
    ds_read_b128 a[52:55], v2 offset:14336
    ds_read_b128 a[56:59], v21 offset:12288
    ds_read_b128 a[60:63], v21 offset:14336
    buffer_store_dwordx4 v[34:37], v3, s[16:19], s66 offen sc1
    buffer_store_dwordx4 v[34:37], v3, s[16:19], s67 offen sc1
    s_sub_u32 s79, s67, 4096
    buffer_store_dwordx4 v[34:37], v3, s[16:19], s79 offen sc1
    s_waitcnt vmcnt(11)
    ds_read_b128 v[82:85], v69
    ds_read_b128 v[86:89], v71
    s_waitcnt lgkmcnt(0)
    ds_write_b128 v12, v[82:85] offset:0
    ds_write_b128 v12, v[86:89] offset:1024
    v_lshlrev_b32_e64 v66, 16, v82
    v_and_b32 v67, 0xffff0000, v82
    v_lshlrev_b32_e64 v68, 16, v83
    v_and_b32 v69, 0xffff0000, v83
    v_lshlrev_b32_e64 v70, 16, v84
    v_and_b32 v71, 0xffff0000, v84
    v_lshlrev_b32_e64 v72, 16, v85
    v_and_b32 v73, 0xffff0000, v85
    v_lshlrev_b32_e64 v74, 16, v86
    v_and_b32 v75, 0xffff0000, v86
    v_lshlrev_b32_e64 v76, 16, v87
    v_and_b32 v77, 0xffff0000, v87
    v_lshlrev_b32_e64 v78, 16, v88
    v_and_b32 v79, 0xffff0000, v88
    v_lshlrev_b32_e64 v80, 16, v89
    v_and_b32 v81, 0xffff0000, v89
    s_add_u32 m0, s65, 24576
    s_add_u32 s63, s61, 0
    buffer_load_dwordx4 v8, s[12:15], s63 offen offset:0 lds
    buffer_load_dwordx4 v9, s[12:15], s63 offen offset:1024 lds
    buffer_load_dwordx4 v10, s[12:15], s63 offen offset:2048 lds
    buffer_load_dwordx4 v11, s[12:15], s63 offen offset:3072 lds
    s_add_u32 m0, s65, 28672
    s_add_u32 s64, s62, 0
    buffer_load_dwordx4 v8, s[12:15], s64 offen offset:0 lds
    buffer_load_dwordx4 v9, s[12:15], s64 offen offset:1024 lds
    buffer_load_dwordx4 v10, s[12:15], s64 offen offset:2048 lds
    buffer_load_dwordx4 v11, s[12:15], s64 offen offset:3072 lds
    v_lshlrev_b32_e64 v42, 16, v38
    v_and_b32 v43, 0xffff0000, v38
    v_lshlrev_b32_e64 v44, 16, v39
    v_and_b32 v45, 0xffff0000, v39
    v_lshlrev_b32_e64 v46, 16, v40
    v_and_b32 v47, 0xffff0000, v40
    v_lshlrev_b32_e64 v48, 16, v41
    v_and_b32 v49, 0xffff0000, v41
    s_mov_b64 exec, 0xffffff
    ds_write_b128 v22, v[42:45]
    ds_write_b128 v22, v[46:49] offset:16
    s_mov_b64 exec, -1
    s_waitcnt vmcnt(8)
    s_waitcnt lgkmcnt(0)
    s_barrier
    s_setprio 2
    ds_read_b128 a[128:131], v13 offset:0
    ds_read_b128 a[132:135], v13 offset:1024
    ds_read_b128 a[136:139], v14 offset:0
    ds_read_b128 a[140:143], v14 offset:1024
    ds_read_b128 a[144:147], v15 offset:0
    ds_read_b128 a[148:151], v15 offset:1024
    v_mfma_f32_16x16x32_bf16 v[26:29], a[0:3], v[82:85], 0
    ds_read_b128 a[64:67], v2 offset:16384
    v_mfma_f32_16x16x32_bf16 v[30:33], a[4:7], v[82:85], 0
    ds_read_b128 a[68:71], v2 offset:18432
    v_mfma_f32_16x16x32_bf16 v[26:29], a[8:11], v[86:89], v[26:29]
    ds_read_b128 a[72:75], v21 offset:16384
    v_mfma_f32_16x16x32_bf16 v[30:33], a[12:15], v[86:89], v[30:33]
    ds_read_b128 a[76:79], v21 offset:18432
    s_waitcnt lgkmcnt(9)
    v_mfma_f32_16x16x32_bf16 v[26:29], a[16:19], a[128:131], v[26:29]
    ds_read_b128 a[80:83], v2 offset:20480
    v_mfma_f32_16x16x32_bf16 v[30:33], a[20:23], a[128:131], v[30:33]
    ds_read_b128 a[84:87], v2 offset:22528
    s_waitcnt lgkmcnt(10)
    v_mfma_f32_16x16x32_bf16 v[26:29], a[24:27], a[132:135], v[26:29]
    ds_read_b128 a[88:91], v21 offset:20480
    v_mfma_f32_16x16x32_bf16 v[30:33], a[28:31], a[132:135], v[30:33]
    ds_read_b128 a[92:95], v21 offset:22528
    s_waitcnt lgkmcnt(11)
    v_mfma_f32_16x16x32_bf16 v[26:29], a[32:35], a[136:139], v[26:29]
    v_mfma_f32_16x16x32_bf16 v[30:33], a[36:39], a[136:139], v[30:33]
    buffer_load_ubyte v23, v24, s[24:27], 0 offen sc1
    s_waitcnt lgkmcnt(10)
    v_mfma_f32_16x16x32_bf16 v[26:29], a[40:43], a[140:143], v[26:29]
    v_mfma_f32_16x16x32_bf16 v[30:33], a[44:47], a[140:143], v[30:33]
    s_waitcnt lgkmcnt(9)
    v_mfma_f32_16x16x32_bf16 v[26:29], a[48:51], a[144:147], v[26:29]
    v_mfma_f32_16x16x32_bf16 v[30:33], a[52:55], a[144:147], v[30:33]
    s_waitcnt lgkmcnt(8)
    v_mfma_f32_16x16x32_bf16 v[26:29], a[56:59], a[148:151], v[26:29]
    v_mfma_f32_16x16x32_bf16 v[30:33], a[60:63], a[148:151], v[30:33]
    s_nop 6
    v_cvt_pk_bf16_f32 v90, v26, v27
    v_cvt_pk_bf16_f32 v91, v28, v29
    v_cvt_pk_bf16_f32 v92, v30, v31
    v_cvt_pk_bf16_f32 v93, v32, v33
    v_and_or_b32 v90, v90, -2, s7
    v_and_or_b32 v91, v91, -2, s7
    v_and_or_b32 v92, v92, -2, s7
    v_and_or_b32 v93, v93, -2, s7
    s_mov_b32 s70, 0
    s_mov_b32 s54, 1
    s_or_b32 s77, s53, 32
    s_waitcnt vmcnt(0)
    v_readfirstlane_b32 s71, v23
    s_and_b32 s71, s71, 63
    s_cmp_eq_u32 s71, s77
    s_cbranch_scc0 L_hs_fast1
L_hs_done1:
    s_xor_b32 s79, s5, 512
    s_cmp_eq_u32 s54, 0
    s_cbranch_scc1 L_ss10
    buffer_store_dwordx4 v[90:93], v3, s[20:23], s79 offen
L_sd10:
    v_lshlrev_b32_e64 v50, 16, v82
    v_and_b32 v51, 0xffff0000, v82
    v_lshlrev_b32_e64 v52, 16, v83
    v_and_b32 v53, 0xffff0000, v83
    v_lshlrev_b32_e64 v54, 16, v84
    v_and_b32 v55, 0xffff0000, v84
    v_lshlrev_b32_e64 v56, 16, v85
    v_and_b32 v57, 0xffff0000, v85
    v_lshlrev_b32_e64 v58, 16, v86
    v_and_b32 v59, 0xffff0000, v86
    v_lshlrev_b32_e64 v60, 16, v87
    v_and_b32 v61, 0xffff0000, v87
    v_lshlrev_b32_e64 v62, 16, v88
    v_and_b32 v63, 0xffff0000, v88
    v_lshlrev_b32_e64 v64, 16, v89
    v_and_b32 v65, 0xffff0000, v89
    s_setprio 0
    s_waitcnt lgkmcnt(0)
    s_barrier
    ds_read_b128 a[96:99], v2 offset:24576
    ds_read_b128 a[100:103], v2 offset:26624
    ds_read_b128 a[104:107], v21 offset:24576
    ds_read_b128 a[108:111], v21 offset:26624
    ds_read_b128 a[112:115], v2 offset:28672
    ds_read_b128 a[116:119], v2 offset:30720
    ds_read_b128 a[120:123], v21 offset:28672
    ds_read_b128 a[124:127], v21 offset:30720
    s_add_u32 m0, s65, 8192
    s_add_u32 s63, s57, 131072
    buffer_load_dwordx4 v4, s[8:11], s63 offen offset:0 lds
    buffer_load_dwordx4 v5, s[8:11], s63 offen offset:1024 lds
    buffer_load_dword v0, off, s[28:31], 0
    buffer_load_dwordx4 v6, s[8:11], s63 offen offset:2048 lds
    buffer_load_dwordx4 v7, s[8:11], s63 offen offset:3072 lds
    buffer_load_dword v0, off, s[28:31], 0
    s_add_u32 m0, s65, 12288
    s_add_u32 s64, s58, 131072
    buffer_load_dwordx4 v4, s[8:11], s64 offen offset:0 lds
    buffer_load_dwordx4 v5, s[8:11], s64 offen offset:1024 lds
    buffer_load_dword v0, off, s[28:31], 0
    buffer_load_dwordx4 v6, s[8:11], s64 offen offset:2048 lds
    buffer_load_dwordx4 v7, s[8:11], s64 offen offset:3072 lds
    buffer_load_dword v0, off, s[28:31], 0
    s_waitcnt lgkmcnt(0)
    s_barrier
    s_mov_b32 s4, 131072
    s_mov_b32 s3, 4
    .p2align 6
L_loop1:
    s_add_u32 m0, s65, 16384
    s_add_u32 s63, s59, s4
    buffer_load_dwordx4 v8, s[12:15], s63 offen offset:0 lds
    buffer_load_dword v0, off, s[28:31], 0
    ds_read_b128 a[0:3], v2 offset:0
    ds_read_b128 a[4:7], v2 offset:2048
    ds_read_b128 a[8:11], v21 offset:0
    ds_read_b128 a[12:15], v21 offset:2048
    buffer_load_dwordx4 v9, s[12:15], s63 offen offset:1024 lds
    buffer_load_dword v0, off, s[28:31], 0
    ds_read_b128 a[16:19], v2 offset:4096
    ds_read_b128 a[20:23], v2 offset:6144
    ds_read_b128 a[24:27], v21 offset:4096
    ds_read_b128 a[28:31], v21 offset:6144
    buffer_load_dwordx4 v[94:97], v3, s[20:23], s5 offen sc1
    buffer_load_dwordx4 v10, s[12:15], s63 offen offset:2048 lds
    buffer_load_dword v0, off, s[28:31], 0
    ds_read_b128 v[34:37], v20 offset:0
    ds_read_b128 v[38:41], v20 offset:16
    ds_read_b128 v[42:45], v20 offset:128
    ds_read_b128 v[46:49], v20 offset:144
    buffer_load_dwordx4 v11, s[12:15], s63 offen offset:3072 lds
    buffer_load_dword v0, off, s[28:31], 0
    s_add_u32 m0, s65, 20480
    s_add_u32 s64, s60, s4
    buffer_load_dwordx4 v8, s[12:15], s64 offen offset:0 lds
    buffer_load_dwordx4 v9, s[12:15], s64 offen offset:1024 lds
    buffer_load_dwordx4 v10, s[12:15], s64 offen offset:2048 lds
    buffer_load_dwordx4 v11, s[12:15], s64 offen offset:3072 lds
    s_waitcnt vmcnt(13)
    s_waitcnt lgkmcnt(0)
    s_barrier
    s_add_u32 m0, s65, 24576
    s_add_u32 s63, s61, s4
    buffer_load_dwordx4 v8, s[12:15], s63 offen offset:0 lds
    buffer_load_dwordx4 v9, s[12:15], s63 offen offset:1024 lds
    buffer_load_dwordx4 v10, s[12:15], s63 offen offset:2048 lds
    ds_read_b128 a[32:35], v2 offset:8192
    ds_read_b128 a[36:39], v2 offset:10240
    ds_read_b128 a[40:43], v21 offset:8192
    ds_read_b128 a[44:47], v21 offset:10240
    buffer_load_dwordx4 v11, s[12:15], s63 offen offset:3072 lds
    ds_read_b128 a[48:51], v2 offset:12288
    ds_read_b128 a[52:55], v2 offset:14336
    ds_read_b128 a[56:59], v21 offset:12288
    ds_read_b128 a[60:63], v21 offset:14336
    s_add_u32 m0, s65, 28672
    s_add_u32 s64, s62, s4
    buffer_load_dwordx4 v8, s[12:15], s64 offen offset:0 lds
    s_waitcnt vmcnt(13)
    v_xor_b32_e64 v25, s7, v94
    v_bitop3_b32 v25, v95, v25, s7 bitop3:0xde
    v_bitop3_b32 v25, v96, v25, s7 bitop3:0xde
    v_bitop3_b32 v25, v97, v25, s7 bitop3:0xde
    v_and_b32 v25, 1, v25
    v_cmp_ne_u32 vcc, 0, v25
    s_cbranch_vccnz L_rt11
L_got11:
    v_lshlrev_b32 v98, 16, v94
    v_and_b32 v99, 0xffff0000, v94
    v_lshlrev_b32_e64 v100, 16, v95
    v_and_b32 v101, 0xffff0000, v95
    v_add_f32 v98, v98, v26
    v_add_f32 v99, v99, v27
    v_add_f32 v100, v100, v28
    v_add_f32 v101, v101, v29
    v_cvt_pk_bf16_f32 v90, v98, v99
    v_cvt_pk_bf16_f32 v91, v100, v101
    buffer_load_dwordx4 v9, s[12:15], s64 offen offset:1024 lds
    v_lshlrev_b32_e64 v98, 16, v96
    v_and_b32 v99, 0xffff0000, v96
    v_lshlrev_b32_e64 v100, 16, v97
    v_and_b32 v101, 0xffff0000, v97
    v_add_f32 v98, v98, v30
    v_add_f32 v99, v99, v31
    v_add_f32 v100, v100, v32
    v_add_f32 v101, v101, v33
    v_cvt_pk_bf16_f32 v92, v98, v99
    v_cvt_pk_bf16_f32 v93, v100, v101
    ds_write_b128 v16, v[90:93]
    s_xor_b32 s5, s5, 16384
    s_lshr_b32 s6, s6, 1
    s_and_b32 s7, s6, 1
    s_waitcnt vmcnt(6)
    buffer_load_dwordx4 v10, s[12:15], s64 offen offset:2048 lds
    buffer_load_dwordx4 v11, s[12:15], s64 offen offset:3072 lds
    buffer_load_dword v0, off, s[28:31], 0
    s_waitcnt lgkmcnt(0)
    s_barrier
    s_setprio 2
    ds_read_b128 a[128:131], v17
    ds_read_b128 a[132:135], v18
    ds_read_b128 a[136:139], v19
    v_mfma_f32_16x16x32_bf16 v[34:37], a[64:67], v[90:93], v[34:37]
    v_mfma_f32_16x16x32_bf16 v[38:41], a[68:71], v[90:93], v[38:41]
    v_mfma_f32_16x16x32_bf16 v[42:45], a[80:83], v[90:93], v[42:45]
    v_mfma_f32_16x16x32_bf16 v[46:49], a[84:87], v[90:93], v[46:49]
    s_waitcnt lgkmcnt(2)
    v_mfma_f32_16x16x32_bf16 v[34:37], a[72:75], a[128:131], v[34:37]
    v_mfma_f32_16x16x32_bf16 v[38:41], a[76:79], a[128:131], v[38:41]
    s_waitcnt lgkmcnt(1)
    v_mfma_f32_16x16x32_bf16 v[34:37], a[96:99], a[132:135], v[34:37]
    ds_read_b128 a[64:67], v2 offset:16384
    v_mfma_f32_16x16x32_bf16 v[38:41], a[100:103], a[132:135], v[38:41]
    ds_read_b128 a[68:71], v2 offset:18432
    s_waitcnt lgkmcnt(2)
    v_mfma_f32_16x16x32_bf16 v[34:37], a[104:107], a[136:139], v[34:37]
    ds_read_b128 a[72:75], v21 offset:16384
    v_mfma_f32_16x16x32_bf16 v[38:41], a[108:111], a[136:139], v[38:41]
    ds_read_b128 a[76:79], v21 offset:18432
    v_mfma_f32_16x16x32_bf16 v[42:45], a[88:91], a[128:131], v[42:45]
    v_mfma_f32_16x16x32_bf16 v[46:49], a[92:95], a[128:131], v[46:49]
    v_mfma_f32_16x16x32_bf16 v[42:45], a[112:115], a[132:135], v[42:45]
    ds_read_b128 a[80:83], v2 offset:20480
    ds_read_b128 a[84:87], v2 offset:22528
    v_mfma_f32_16x16x32_bf16 v[46:49], a[116:119], a[132:135], v[46:49]
    ds_read_b128 a[88:91], v21 offset:20480
    ds_read_b128 a[92:95], v21 offset:22528
    v_mfma_f32_16x16x32_bf16 v[42:45], a[120:123], a[136:139], v[42:45]
    v_fma_f32 v34, v66, v34, v50
    v_fma_f32 v35, v67, v35, v51
    v_mfma_f32_16x16x32_bf16 v[46:49], a[124:127], a[136:139], v[46:49]
    v_fma_f32 v36, v68, v36, v52
    v_fma_f32 v37, v69, v37, v53
    v_fma_f32 v38, v70, v38, v54
    v_fma_f32 v39, v71, v39, v55
    v_fma_f32 v40, v72, v40, v56
    v_fma_f32 v41, v73, v41, v57
    v_cvt_pk_bf16_f32 v82, v34, v35
    v_cvt_pk_bf16_f32 v83, v36, v37
    v_cvt_pk_bf16_f32 v84, v38, v39
    v_cvt_pk_bf16_f32 v85, v40, v41
    ds_write_b128 v12, v[82:85] offset:0
    v_pk_fma_f32 v[42:43], v[74:75], v[42:43], v[58:59]
    v_pk_fma_f32 v[44:45], v[76:77], v[44:45], v[60:61]
    v_pk_fma_f32 v[46:47], v[78:79], v[46:47], v[62:63]
    v_pk_fma_f32 v[48:49], v[80:81], v[48:49], v[64:65]
    v_cvt_pk_bf16_f32 v86, v42, v43
    v_cvt_pk_bf16_f32 v87, v44, v45
    v_cvt_pk_bf16_f32 v88, v46, v47
    v_cvt_pk_bf16_f32 v89, v48, v49
    ds_write_b128 v12, v[86:89] offset:1024
    s_waitcnt vmcnt(1)
    s_waitcnt lgkmcnt(0)
    s_barrier
    ds_read_b128 a[128:131], v13 offset:0
    ds_read_b128 a[132:135], v13 offset:1024
    ds_read_b128 a[136:139], v14 offset:0
    ds_read_b128 a[140:143], v14 offset:1024
    ds_read_b128 a[144:147], v15 offset:0
    ds_read_b128 a[148:151], v15 offset:1024
    v_mfma_f32_16x16x32_bf16 v[26:29], a[0:3], v[82:85], 0
    ds_read_b128 a[96:99], v2 offset:24576
    v_mfma_f32_16x16x32_bf16 v[30:33], a[4:7], v[82:85], 0
    ds_read_b128 a[100:103], v2 offset:26624
    v_mfma_f32_16x16x32_bf16 v[26:29], a[8:11], v[86:89], v[26:29]
    ds_read_b128 a[104:107], v21 offset:24576
    v_mfma_f32_16x16x32_bf16 v[30:33], a[12:15], v[86:89], v[30:33]
    ds_read_b128 a[108:111], v21 offset:26624
    s_waitcnt lgkmcnt(9)
    v_mfma_f32_16x16x32_bf16 v[26:29], a[16:19], a[128:131], v[26:29]
    ds_read_b128 a[112:115], v2 offset:28672
    v_mfma_f32_16x16x32_bf16 v[30:33], a[20:23], a[128:131], v[30:33]
    ds_read_b128 a[116:119], v2 offset:30720
    s_waitcnt lgkmcnt(10)
    v_mfma_f32_16x16x32_bf16 v[26:29], a[24:27], a[132:135], v[26:29]
    ds_read_b128 a[120:123], v21 offset:28672
    v_mfma_f32_16x16x32_bf16 v[30:33], a[28:31], a[132:135], v[30:33]
    ds_read_b128 a[124:127], v21 offset:30720
    s_waitcnt lgkmcnt(11)
    v_mfma_f32_16x16x32_bf16 v[26:29], a[32:35], a[136:139], v[26:29]
    v_mfma_f32_16x16x32_bf16 v[30:33], a[36:39], a[136:139], v[30:33]
    s_waitcnt lgkmcnt(10)
    v_mfma_f32_16x16x32_bf16 v[26:29], a[40:43], a[140:143], v[26:29]
    v_mfma_f32_16x16x32_bf16 v[30:33], a[44:47], a[140:143], v[30:33]
    s_waitcnt lgkmcnt(9)
    v_mfma_f32_16x16x32_bf16 v[26:29], a[48:51], a[144:147], v[26:29]
    v_mfma_f32_16x16x32_bf16 v[30:33], a[52:55], a[144:147], v[30:33]
    s_waitcnt lgkmcnt(8)
    v_mfma_f32_16x16x32_bf16 v[26:29], a[56:59], a[148:151], v[26:29]
    v_mfma_f32_16x16x32_bf16 v[30:33], a[60:63], a[148:151], v[30:33]
    s_nop 6
    v_cvt_pk_bf16_f32 v90, v26, v27
    v_cvt_pk_bf16_f32 v91, v28, v29
    v_cvt_pk_bf16_f32 v92, v30, v31
    v_cvt_pk_bf16_f32 v93, v32, v33
    v_and_or_b32 v90, v90, -2, s7
    v_and_or_b32 v91, v91, -2, s7
    v_and_or_b32 v92, v92, -2, s7
    v_and_or_b32 v93, v93, -2, s7
    s_xor_b32 s79, s5, 512
    s_cmp_eq_u32 s54, 0
    s_cbranch_scc1 L_ss12
    buffer_store_dwordx4 v[90:93], v3, s[20:23], s79 offen
L_sd12:
    v_lshlrev_b32 v50, 16, v82
    v_and_b32 v51, 0xffff0000, v82
    v_lshlrev_b32_e64 v52, 16, v83
    v_and_b32 v53, 0xffff0000, v83
    v_lshlrev_b32_e64 v54, 16, v84
    v_and_b32 v55, 0xffff0000, v84
    v_lshlrev_b32_e64 v56, 16, v85
    v_and_b32 v57, 0xffff0000, v85
    v_lshlrev_b32_e64 v58, 16, v86
    v_and_b32 v59, 0xffff0000, v86
    v_lshlrev_b32_e64 v60, 16, v87
    v_and_b32 v61, 0xffff0000, v87
    v_lshlrev_b32_e64 v62, 16, v88
    v_and_b32 v63, 0xffff0000, v88
    v_lshlrev_b32_e64 v64, 16, v89
    v_and_b32 v65, 0xffff0000, v89
    s_setprio 0
    s_waitcnt lgkmcnt(0)
    s_add_u32 s4, s4, 131072
    v_add_u32 v20, 256, v20
    s_sub_u32 s3, s3, 1
    s_cmp_lg_u32 s3, 0
    s_barrier
    s_cbranch_scc1 L_loop1
    s_add_u32 m0, s65, 16384
    s_add_u32 s63, s59, s4
    buffer_load_dwordx4 v8, s[12:15], s63 offen offset:0 lds
    buffer_load_dword v0, off, s[28:31], 0
    ds_read_b128 a[0:3], v2 offset:0
    ds_read_b128 a[4:7], v2 offset:2048
    ds_read_b128 a[8:11], v21 offset:0
    ds_read_b128 a[12:15], v21 offset:2048
    buffer_load_dwordx4 v9, s[12:15], s63 offen offset:1024 lds
    buffer_load_dword v0, off, s[28:31], 0
    ds_read_b128 a[16:19], v2 offset:4096
    ds_read_b128 a[20:23], v2 offset:6144
    ds_read_b128 a[24:27], v21 offset:4096
    ds_read_b128 a[28:31], v21 offset:6144
    buffer_load_dwordx4 v[94:97], v3, s[20:23], s5 offen sc1
    buffer_load_dwordx4 v10, s[12:15], s63 offen offset:2048 lds
    buffer_load_dword v0, off, s[28:31], 0
    ds_read_b128 v[34:37], v20 offset:0
    ds_read_b128 v[38:41], v20 offset:16
    ds_read_b128 v[42:45], v20 offset:128
    ds_read_b128 v[46:49], v20 offset:144
    buffer_load_dwordx4 v11, s[12:15], s63 offen offset:3072 lds
    buffer_load_dword v0, off, s[28:31], 0
    s_add_u32 m0, s65, 20480
    s_add_u32 s64, s60, s4
    buffer_load_dwordx4 v8, s[12:15], s64 offen offset:0 lds
    buffer_load_dwordx4 v9, s[12:15], s64 offen offset:1024 lds
    buffer_load_dwordx4 v10, s[12:15], s64 offen offset:2048 lds
    buffer_load_dwordx4 v11, s[12:15], s64 offen offset:3072 lds
    s_waitcnt vmcnt(13)
    s_waitcnt lgkmcnt(0)
    s_barrier
    s_add_u32 m0, s65, 24576
    s_add_u32 s63, s61, s4
    buffer_load_dwordx4 v8, s[12:15], s63 offen offset:0 lds
    buffer_load_dwordx4 v9, s[12:15], s63 offen offset:1024 lds
    buffer_load_dwordx4 v10, s[12:15], s63 offen offset:2048 lds
    ds_read_b128 a[32:35], v2 offset:8192
    ds_read_b128 a[36:39], v2 offset:10240
    ds_read_b128 a[40:43], v21 offset:8192
    ds_read_b128 a[44:47], v21 offset:10240
    buffer_load_dwordx4 v11, s[12:15], s63 offen offset:3072 lds
    ds_read_b128 a[48:51], v2 offset:12288
    ds_read_b128 a[52:55], v2 offset:14336
    ds_read_b128 a[56:59], v21 offset:12288
    ds_read_b128 a[60:63], v21 offset:14336
    s_add_u32 m0, s65, 28672
    s_add_u32 s64, s62, s4
    buffer_load_dwordx4 v8, s[12:15], s64 offen offset:0 lds
    s_waitcnt vmcnt(13)
    v_xor_b32_e64 v25, s7, v94
    v_bitop3_b32 v25, v95, v25, s7 bitop3:0xde
    v_bitop3_b32 v25, v96, v25, s7 bitop3:0xde
    v_bitop3_b32 v25, v97, v25, s7 bitop3:0xde
    v_and_b32 v25, 1, v25
    v_cmp_ne_u32 vcc, 0, v25
    s_cbranch_vccnz L_rt14
L_got14:
    v_lshlrev_b32 v98, 16, v94
    v_and_b32 v99, 0xffff0000, v94
    v_lshlrev_b32_e64 v100, 16, v95
    v_and_b32 v101, 0xffff0000, v95
    v_add_f32 v98, v98, v26
    v_add_f32 v99, v99, v27
    v_add_f32 v100, v100, v28
    v_add_f32 v101, v101, v29
    v_cvt_pk_bf16_f32 v90, v98, v99
    v_cvt_pk_bf16_f32 v91, v100, v101
    buffer_load_dwordx4 v9, s[12:15], s64 offen offset:1024 lds
    v_lshlrev_b32_e64 v98, 16, v96
    v_and_b32 v99, 0xffff0000, v96
    v_lshlrev_b32_e64 v100, 16, v97
    v_and_b32 v101, 0xffff0000, v97
    v_add_f32 v98, v98, v30
    v_add_f32 v99, v99, v31
    v_add_f32 v100, v100, v32
    v_add_f32 v101, v101, v33
    v_cvt_pk_bf16_f32 v92, v98, v99
    v_cvt_pk_bf16_f32 v93, v100, v101
    ds_write_b128 v16, v[90:93]
    s_xor_b32 s5, s5, 16384
    s_lshr_b32 s6, s6, 1
    s_and_b32 s7, s6, 1
    s_waitcnt vmcnt(6)
    buffer_load_dwordx4 v10, s[12:15], s64 offen offset:2048 lds
    buffer_load_dwordx4 v11, s[12:15], s64 offen offset:3072 lds
    buffer_load_dword v0, off, s[28:31], 0
    s_waitcnt lgkmcnt(0)
    s_barrier
    s_setprio 2
    ds_read_b128 a[128:131], v17
    ds_read_b128 a[132:135], v18
    ds_read_b128 a[136:139], v19
    v_mfma_f32_16x16x32_bf16 v[34:37], a[64:67], v[90:93], v[34:37]
    v_mfma_f32_16x16x32_bf16 v[38:41], a[68:71], v[90:93], v[38:41]
    v_mfma_f32_16x16x32_bf16 v[42:45], a[80:83], v[90:93], v[42:45]
    v_mfma_f32_16x16x32_bf16 v[46:49], a[84:87], v[90:93], v[46:49]
    s_waitcnt lgkmcnt(2)
    v_mfma_f32_16x16x32_bf16 v[34:37], a[72:75], a[128:131], v[34:37]
    v_mfma_f32_16x16x32_bf16 v[38:41], a[76:79], a[128:131], v[38:41]
    s_waitcnt lgkmcnt(1)
    v_mfma_f32_16x16x32_bf16 v[34:37], a[96:99], a[132:135], v[34:37]
    ds_read_b128 a[64:67], v2 offset:16384
    v_mfma_f32_16x16x32_bf16 v[38:41], a[100:103], a[132:135], v[38:41]
    ds_read_b128 a[68:71], v2 offset:18432
    s_waitcnt lgkmcnt(2)
    v_mfma_f32_16x16x32_bf16 v[34:37], a[104:107], a[136:139], v[34:37]
    ds_read_b128 a[72:75], v21 offset:16384
    v_mfma_f32_16x16x32_bf16 v[38:41], a[108:111], a[136:139], v[38:41]
    ds_read_b128 a[76:79], v21 offset:18432
    v_mfma_f32_16x16x32_bf16 v[42:45], a[88:91], a[128:131], v[42:45]
    v_mfma_f32_16x16x32_bf16 v[46:49], a[92:95], a[128:131], v[46:49]
    v_mfma_f32_16x16x32_bf16 v[42:45], a[112:115], a[132:135], v[42:45]
    ds_read_b128 a[80:83], v2 offset:20480
    ds_read_b128 a[84:87], v2 offset:22528
    v_mfma_f32_16x16x32_bf16 v[46:49], a[116:119], a[132:135], v[46:49]
    ds_read_b128 a[88:91], v21 offset:20480
    ds_read_b128 a[92:95], v21 offset:22528
    v_mfma_f32_16x16x32_bf16 v[42:45], a[120:123], a[136:139], v[42:45]
    v_fma_f32 v34, v66, v34, v50
    v_fma_f32 v35, v67, v35, v51
    v_mfma_f32_16x16x32_bf16 v[46:49], a[124:127], a[136:139], v[46:49]
    v_fma_f32 v36, v68, v36, v52
    v_fma_f32 v37, v69, v37, v53
    v_fma_f32 v38, v70, v38, v54
    v_fma_f32 v39, v71, v39, v55
    v_fma_f32 v40, v72, v40, v56
    v_fma_f32 v41, v73, v41, v57
    v_cvt_pk_bf16_f32 v82, v34, v35
    v_cvt_pk_bf16_f32 v83, v36, v37
    v_cvt_pk_bf16_f32 v84, v38, v39
    v_cvt_pk_bf16_f32 v85, v40, v41
    ds_write_b128 v12, v[82:85] offset:0
    v_pk_fma_f32 v[42:43], v[74:75], v[42:43], v[58:59]
    v_pk_fma_f32 v[44:45], v[76:77], v[44:45], v[60:61]
    v_pk_fma_f32 v[46:47], v[78:79], v[46:47], v[62:63]
    v_pk_fma_f32 v[48:49], v[80:81], v[48:49], v[64:65]
    v_cvt_pk_bf16_f32 v86, v42, v43
    v_cvt_pk_bf16_f32 v87, v44, v45
    v_cvt_pk_bf16_f32 v88, v46, v47
    v_cvt_pk_bf16_f32 v89, v48, v49
    ds_write_b128 v12, v[86:89] offset:1024
    s_waitcnt vmcnt(1)
    s_waitcnt lgkmcnt(0)
    s_barrier
    ds_read_b128 a[128:131], v13 offset:0
    ds_read_b128 a[132:135], v13 offset:1024
    ds_read_b128 a[136:139], v14 offset:0
    ds_read_b128 a[140:143], v14 offset:1024
    ds_read_b128 a[144:147], v15 offset:0
    ds_read_b128 a[148:151], v15 offset:1024
    v_mfma_f32_16x16x32_bf16 v[26:29], a[0:3], v[82:85], 0
    ds_read_b128 a[96:99], v2 offset:24576
    v_mfma_f32_16x16x32_bf16 v[30:33], a[4:7], v[82:85], 0
    ds_read_b128 a[100:103], v2 offset:26624
    v_mfma_f32_16x16x32_bf16 v[26:29], a[8:11], v[86:89], v[26:29]
    ds_read_b128 a[104:107], v21 offset:24576
    v_mfma_f32_16x16x32_bf16 v[30:33], a[12:15], v[86:89], v[30:33]
    ds_read_b128 a[108:111], v21 offset:26624
    s_waitcnt lgkmcnt(9)
    v_mfma_f32_16x16x32_bf16 v[26:29], a[16:19], a[128:131], v[26:29]
    ds_read_b128 a[112:115], v2 offset:28672
    v_mfma_f32_16x16x32_bf16 v[30:33], a[20:23], a[128:131], v[30:33]
    ds_read_b128 a[116:119], v2 offset:30720
    s_waitcnt lgkmcnt(10)
    v_mfma_f32_16x16x32_bf16 v[26:29], a[24:27], a[132:135], v[26:29]
    ds_read_b128 a[120:123], v21 offset:28672
    v_mfma_f32_16x16x32_bf16 v[30:33], a[28:31], a[132:135], v[30:33]
    ds_read_b128 a[124:127], v21 offset:30720
    s_waitcnt lgkmcnt(11)
    v_mfma_f32_16x16x32_bf16 v[26:29], a[32:35], a[136:139], v[26:29]
    v_mfma_f32_16x16x32_bf16 v[30:33], a[36:39], a[136:139], v[30:33]
    s_waitcnt lgkmcnt(10)
    v_mfma_f32_16x16x32_bf16 v[26:29], a[40:43], a[140:143], v[26:29]
    v_mfma_f32_16x16x32_bf16 v[30:33], a[44:47], a[140:143], v[30:33]
    s_waitcnt lgkmcnt(9)
    v_mfma_f32_16x16x32_bf16 v[26:29], a[48:51], a[144:147], v[26:29]
    v_mfma_f32_16x16x32_bf16 v[30:33], a[52:55], a[144:147], v[30:33]
    s_waitcnt lgkmcnt(8)
    v_mfma_f32_16x16x32_bf16 v[26:29], a[56:59], a[148:151], v[26:29]
    v_mfma_f32_16x16x32_bf16 v[30:33], a[60:63], a[148:151], v[30:33]
    s_nop 6
    v_cvt_pk_bf16_f32 v90, v26, v27
    v_cvt_pk_bf16_f32 v91, v28, v29
    v_cvt_pk_bf16_f32 v92, v30, v31
    v_cvt_pk_bf16_f32 v93, v32, v33
    v_and_or_b32 v90, v90, -2, s7
    v_and_or_b32 v91, v91, -2, s7
    v_and_or_b32 v92, v92, -2, s7
    v_and_or_b32 v93, v93, -2, s7
    s_xor_b32 s79, s5, 512
    s_cmp_eq_u32 s54, 0
    s_cbranch_scc1 L_ss15
    buffer_store_dwordx4 v[90:93], v3, s[20:23], s79 offen
L_sd15:
    v_lshlrev_b32 v50, 16, v82
    v_and_b32 v51, 0xffff0000, v82
    v_lshlrev_b32_e64 v52, 16, v83
    v_and_b32 v53, 0xffff0000, v83
    v_lshlrev_b32_e64 v54, 16, v84
    v_and_b32 v55, 0xffff0000, v84
    v_lshlrev_b32_e64 v56, 16, v85
    v_and_b32 v57, 0xffff0000, v85
    v_lshlrev_b32_e64 v58, 16, v86
    v_and_b32 v59, 0xffff0000, v86
    v_lshlrev_b32_e64 v60, 16, v87
    v_and_b32 v61, 0xffff0000, v87
    v_lshlrev_b32_e64 v62, 16, v88
    v_and_b32 v63, 0xffff0000, v88
    v_lshlrev_b32_e64 v64, 16, v89
    v_and_b32 v65, 0xffff0000, v89
    v_and_b32 v94, 15, v1
    v_lshrrev_b32 v95, 4, v1
    v_and_b32 v96, 7, v94
    v_xor_b32 v96, v96, v95
    v_lshlrev_b32_e64 v96, 4, v96
    v_lshl_add_u32 v96, v94, 7, v96
    v_and_b32 v22, 0xfffff800, v12
    v_add_u32 v22, v22, v96
    v_xor_b32 v23, 64, v22
    v_lshrrev_b32 v94, 3, v1
    v_xor_b32 v95, v94, v1
    v_and_b32 v95, 7, v95
    v_lshlrev_b32 v95, 4, v95
    v_and_b32 v96, 4, v94
    v_add_u32 v94, v94, v96
    v_lshl_add_u32 v24, v94, 10, v95
    s_setprio 0
    s_waitcnt lgkmcnt(0)
    s_add_u32 s4, s4, 131072
    v_add_u32 v20, 256, v20
    s_barrier
    buffer_load_dwordx4 v[94:97], v3, s[20:23], s5 offen sc1
    ds_read_b128 v[34:37], v20 offset:0
    ds_read_b128 v[38:41], v20 offset:16
    ds_read_b128 v[42:45], v20 offset:128
    ds_read_b128 v[46:49], v20 offset:144
    s_waitcnt vmcnt(0)
    v_xor_b32_e64 v25, s7, v94
    v_bitop3_b32 v25, v95, v25, s7 bitop3:0xde
    v_bitop3_b32 v25, v96, v25, s7 bitop3:0xde
    v_bitop3_b32 v25, v97, v25, s7 bitop3:0xde
    v_and_b32 v25, 1, v25
    v_cmp_ne_u32 vcc, 0, v25
    s_cbranch_vccnz L_rt15
L_got15:
    v_lshlrev_b32 v98, 16, v94
    v_and_b32 v99, 0xffff0000, v94
    v_lshlrev_b32_e64 v100, 16, v95
    v_and_b32 v101, 0xffff0000, v95
    v_add_f32 v98, v98, v26
    v_add_f32 v99, v99, v27
    v_add_f32 v100, v100, v28
    v_add_f32 v101, v101, v29
    v_cvt_pk_bf16_f32 v90, v98, v99
    v_cvt_pk_bf16_f32 v91, v100, v101
    v_lshlrev_b32_e64 v98, 16, v96
    v_and_b32 v99, 0xffff0000, v96
    v_lshlrev_b32_e64 v100, 16, v97
    v_and_b32 v101, 0xffff0000, v97
    v_add_f32 v98, v98, v30
    v_add_f32 v99, v99, v31
    v_add_f32 v100, v100, v32
    v_add_f32 v101, v101, v33
    v_cvt_pk_bf16_f32 v92, v98, v99
    v_cvt_pk_bf16_f32 v93, v100, v101
    ds_write_b128 v16, v[90:93]
    s_xor_b32 s5, s5, 16384
    s_lshr_b32 s6, s6, 1
    s_and_b32 s7, s6, 1
    s_waitcnt lgkmcnt(0)
    s_barrier
    s_setprio 2
    ds_read_b128 a[128:131], v17
    ds_read_b128 a[132:135], v18
    ds_read_b128 a[136:139], v19
    v_mfma_f32_16x16x32_bf16 v[34:37], a[64:67], v[90:93], v[34:37]
    v_mfma_f32_16x16x32_bf16 v[38:41], a[68:71], v[90:93], v[38:41]
    v_mfma_f32_16x16x32_bf16 v[42:45], a[80:83], v[90:93], v[42:45]
    v_mfma_f32_16x16x32_bf16 v[46:49], a[84:87], v[90:93], v[46:49]
    s_waitcnt lgkmcnt(2)
    v_mfma_f32_16x16x32_bf16 v[34:37], a[72:75], a[128:131], v[34:37]
    v_mfma_f32_16x16x32_bf16 v[38:41], a[76:79], a[128:131], v[38:41]
    s_waitcnt lgkmcnt(1)
    v_mfma_f32_16x16x32_bf16 v[34:37], a[96:99], a[132:135], v[34:37]
    v_mfma_f32_16x16x32_bf16 v[38:41], a[100:103], a[132:135], v[38:41]
    s_waitcnt lgkmcnt(0)
    v_mfma_f32_16x16x32_bf16 v[34:37], a[104:107], a[136:139], v[34:37]
    v_mfma_f32_16x16x32_bf16 v[38:41], a[108:111], a[136:139], v[38:41]
    v_mfma_f32_16x16x32_bf16 v[42:45], a[88:91], a[128:131], v[42:45]
    v_mfma_f32_16x16x32_bf16 v[46:49], a[92:95], a[128:131], v[46:49]
    v_mfma_f32_16x16x32_bf16 v[42:45], a[112:115], a[132:135], v[42:45]
    v_mfma_f32_16x16x32_bf16 v[46:49], a[116:119], a[132:135], v[46:49]
    v_mfma_f32_16x16x32_bf16 v[42:45], a[120:123], a[136:139], v[42:45]
    s_nop 1
    v_fma_f32 v34, v66, v34, v50
    v_fma_f32 v35, v67, v35, v51
    v_mfma_f32_16x16x32_bf16 v[46:49], a[124:127], a[136:139], v[46:49]
    v_fma_f32 v36, v68, v36, v52
    v_fma_f32 v37, v69, v37, v53
    v_fma_f32 v38, v70, v38, v54
    v_fma_f32 v39, v71, v39, v55
    v_fma_f32 v40, v72, v40, v56
    v_fma_f32 v41, v73, v41, v57
    v_cvt_pk_bf16_f32 v82, v34, v35
    v_cvt_pk_bf16_f32 v83, v36, v37
    v_cvt_pk_bf16_f32 v84, v38, v39
    v_cvt_pk_bf16_f32 v85, v40, v41
    ds_write_b128 v22, v[82:85]
    v_pk_fma_f32 v[42:43], v[74:75], v[42:43], v[58:59]
    v_pk_fma_f32 v[44:45], v[76:77], v[44:45], v[60:61]
    v_pk_fma_f32 v[46:47], v[78:79], v[46:47], v[62:63]
    v_pk_fma_f32 v[48:49], v[80:81], v[48:49], v[64:65]
    v_cvt_pk_bf16_f32 v86, v42, v43
    v_cvt_pk_bf16_f32 v87, v44, v45
    v_cvt_pk_bf16_f32 v88, v46, v47
    v_cvt_pk_bf16_f32 v89, v48, v49
    ds_write_b128 v23, v[86:89]
    ds_read_b128 v[50:53], v12 offset:0
    ds_read_b128 v[54:57], v12 offset:1024
    s_add_u32 s71, s78, 0
    s_waitcnt lgkmcnt(1)
    buffer_store_dwordx4 v[50:53], v24, s[16:19], s71 offen
    s_add_u32 s72, s78, 16384
    s_waitcnt lgkmcnt(0)
    buffer_store_dwordx4 v[54:57], v24, s[16:19], s72 offen
    s_endpgm
L_end:
    s_endpgm
L_hs_fast0:
    buffer_load_ubyte v23, v24, s[24:27], 0 offen sc1
    s_waitcnt vmcnt(0)
    v_readfirstlane_b32 s71, v23
    s_and_b32 s71, s71, 31
    s_cmp_eq_u32 s71, s77
    s_cbranch_scc1 L_hs_done0
    s_sleep 1
    s_add_u32 s70, s70, 1
    s_cmp_lt_u32 s70, 24
    s_cbranch_scc1 L_hs_fast0
    v_mov_b32 v54, 0
    v_mov_b32 v55, 0
    v_mov_b32 v56, 0
    v_mov_b32 v57, 0
    buffer_store_dwordx4 v[54:57], v3, s[32:35], s66 offen sc1
    buffer_store_dwordx4 v[54:57], v3, s[32:35], s67 offen sc1
    s_lshl_b32 s72, s2, 3
    s_add_u32 s72, s72, s50
    s_lshl_b32 s72, s72, 7
    s_add_u32 s72, s72, 4194304
    s_xor_b32 s73, s72, 8192
    v_mov_b32 v52, 0
    s_mov_b64 exec, 1
    buffer_load_dwordx4 v[58:61], v52, s[32:35], s73 offen sc1
    s_waitcnt vmcnt(0)
    v_readfirstlane_b32 s74, v60
    s_add_u32 s74, s74, 1
    s_nop 0
    v_mov_b32 v53, s74
    buffer_store_dword v53, v52, s[32:35], s72 offen sc1
    s_waitcnt vmcnt(0)
    s_mov_b32 s70, 0
L_hs_slow0:
    buffer_load_ubyte v23, v24, s[24:27], 0 offen sc1
    buffer_load_dwordx4 v[58:61], v52, s[32:35], s73 offen sc1
    s_waitcnt vmcnt(0)
    v_readfirstlane_b32 s71, v23
    v_readfirstlane_b32 s76, v58
    v_readfirstlane_b32 s75, v60
    v_readfirstlane_b32 s54, v61
    s_and_b32 s71, s71, 31
    s_cmp_eq_u32 s71, s77
    s_cbranch_scc1 L_hs_same0
    s_cmp_eq_u32 s70, 0
    s_cbranch_scc1 L_hs_ans0
    s_cmp_eq_u32 s76, s51
    s_cbranch_scc1 L_hs_noans0
L_hs_ans0:
    s_mov_b32 s51, s76
    v_mov_b32 v62, s76
    v_mov_b32 v63, s53
    buffer_store_dwordx2 v[62:63], v52, s[32:35], s72 offen offset:8 sc1
L_hs_noans0:
    s_sleep 4
    s_add_u32 s70, s70, 1
    s_cmp_gt_u32 s70, 0x200000
    s_cbranch_scc1 L_hs_same0
    s_cmp_eq_u32 s75, s74
    s_cbranch_scc0 L_hs_slow0
    s_cmp_eq_u32 s54, s53
    s_cbranch_scc1 L_hs_same0
    s_mov_b32 s54, 0
    s_mov_b32 s20, s48
    s_mov_b32 s21, s49
    s_mov_b64 exec, -1
    s_branch L_hs_done0
L_hs_same0:
    s_mov_b32 s54, 1
    s_mov_b64 exec, -1
    s_branch L_hs_done0
L_ss00:
    buffer_store_dwordx4 v[90:93], v3, s[20:23], s79 offen sc1
    s_nop 1
    s_branch L_sd00
L_rt00:
    s_mov_b32 s70, 0
L_rl00:
    buffer_load_dwordx4 v[94:97], v3, s[20:23], s5 offen sc1
    s_add_u32 s70, s70, 1
    s_cmp_gt_u32 s70, 0x200000
    s_waitcnt vmcnt(0)
    s_cbranch_scc1 L_got00
    v_xor_b32 v25, s7, v94
    v_bitop3_b32 v25, v95, v25, s7 bitop3:0xde
    v_bitop3_b32 v25, v96, v25, s7 bitop3:0xde
    v_bitop3_b32 v25, v97, v25, s7 bitop3:0xde
    v_and_b32 v25, 1, v25
    v_cmp_ne_u32 vcc, 0, v25
    s_cbranch_vccz L_got00
    s_sleep 1
    s_branch L_rl00
L_ss02:
    buffer_store_dwordx4 v[90:93], v3, s[20:23], s79 offen sc1
    s_nop 1
    s_branch L_sd02
L_rt02:
    s_mov_b32 s70, 0
L_rl02:
    buffer_load_dwordx4 v[94:97], v3, s[20:23], s5 offen sc1
    s_add_u32 s70, s70, 1
    s_cmp_gt_u32 s70, 0x200000
    s_waitcnt vmcnt(0)
    s_cbranch_scc1 L_got02
    v_xor_b32 v25, s7, v94
    v_bitop3_b32 v25, v95, v25, s7 bitop3:0xde
    v_bitop3_b32 v25, v96, v25, s7 bitop3:0xde
    v_bitop3_b32 v25, v97, v25, s7 bitop3:0xde
    v_and_b32 v25, 1, v25
    v_cmp_ne_u32 vcc, 0, v25
    s_cbranch_vccz L_got02
    s_sleep 1
    s_branch L_rl02
L_ss05:
    buffer_store_dwordx4 v[90:93], v3, s[20:23], s79 offen sc1
    s_nop 1
    s_branch L_sd05
L_rt05:
    s_mov_b32 s70, 0
L_rl05:
    buffer_load_dwordx4 v[94:97], v3, s[20:23], s5 offen sc1
    s_add_u32 s70, s70, 1
    s_cmp_gt_u32 s70, 0x200000
    s_waitcnt vmcnt(0)
    s_cbranch_scc1 L_got05
    v_xor_b32 v25, s7, v94
    v_bitop3_b32 v25, v95, v25, s7 bitop3:0xde
    v_bitop3_b32 v25, v96, v25, s7 bitop3:0xde
    v_bitop3_b32 v25, v97, v25, s7 bitop3:0xde
    v_and_b32 v25, 1, v25
    v_cmp_ne_u32 vcc, 0, v25
    s_cbranch_vccz L_got05
    s_sleep 1
    s_branch L_rl05
L_hs_fast1:
    buffer_load_ubyte v23, v24, s[24:27], 0 offen sc1
    s_waitcnt vmcnt(0)
    v_readfirstlane_b32 s71, v23
    s_and_b32 s71, s71, 63
    s_cmp_eq_u32 s71, s77
    s_cbranch_scc1 L_hs_done1
    s_sleep 1
    s_add_u32 s70, s70, 1
    s_cmp_lt_u32 s70, 24
    s_cbranch_scc1 L_hs_fast1
    v_mov_b32 v54, 0
    v_mov_b32 v55, 0
    v_mov_b32 v56, 0
    v_mov_b32 v57, 0
    buffer_store_dwordx4 v[54:57], v3, s[32:35], s66 offen sc1
    buffer_store_dwordx4 v[54:57], v3, s[32:35], s67 offen sc1
    s_lshl_b32 s72, s2, 3
    s_add_u32 s72, s72, s50
    s_lshl_b32 s72, s72, 7
    s_add_u32 s72, s72, 4194304
    s_xor_b32 s73, s72, 8192
    v_mov_b32 v52, 0
    s_mov_b64 exec, 1
    buffer_load_dwordx4 v[58:61], v52, s[32:35], s73 offen sc1
    s_waitcnt vmcnt(0)
    v_readfirstlane_b32 s74, v60
    s_add_u32 s74, s74, 1
    s_nop 0
    v_mov_b32 v53, s74
    buffer_store_dword v53, v52, s[32:35], s72 offen sc1
    s_waitcnt vmcnt(0)
    s_mov_b32 s70, 0
L_hs_slow1:
    buffer_load_ubyte v23, v24, s[24:27], 0 offen sc1
    buffer_load_dwordx4 v[58:61], v52, s[32:35], s73 offen sc1
    s_waitcnt vmcnt(0)
    v_readfirstlane_b32 s71, v23
    v_readfirstlane_b32 s76, v58
    v_readfirstlane_b32 s75, v60
    v_readfirstlane_b32 s54, v61
    s_and_b32 s71, s71, 63
    s_cmp_eq_u32 s71, s77
    s_cbranch_scc1 L_hs_same1
    s_cmp_eq_u32 s70, 0
    s_cbranch_scc1 L_hs_ans1
    s_cmp_eq_u32 s76, s51
    s_cbranch_scc1 L_hs_noans1
L_hs_ans1:
    s_mov_b32 s51, s76
    v_mov_b32 v62, s76
    v_mov_b32 v63, s53
    buffer_store_dwordx2 v[62:63], v52, s[32:35], s72 offen offset:8 sc1
L_hs_noans1:
    s_sleep 4
    s_add_u32 s70, s70, 1
    s_cmp_gt_u32 s70, 0x200000
    s_cbranch_scc1 L_hs_same1
    s_cmp_eq_u32 s75, s74
    s_cbranch_scc0 L_hs_slow1
    s_cmp_eq_u32 s54, s53
    s_cbranch_scc1 L_hs_same1
    s_mov_b32 s54, 0
    s_mov_b32 s20, s48
    s_mov_b32 s21, s49
    s_mov_b64 exec, -1
    s_branch L_hs_done1
L_hs_same1:
    s_mov_b32 s54, 1
    s_mov_b64 exec, -1
    s_branch L_hs_done1
L_ss10:
    buffer_store_dwordx4 v[90:93], v3, s[20:23], s79 offen sc1
    s_nop 1
    s_branch L_sd10
L_rt11:
    s_mov_b32 s70, 0
L_rl11:
    buffer_load_dwordx4 v[94:97], v3, s[20:23], s5 offen sc1
    s_add_u32 s70, s70, 1
    s_cmp_gt_u32 s70, 0x200000
    s_waitcnt vmcnt(0)
    s_cbranch_scc1 L_got11
    v_xor_b32 v25, s7, v94
    v_bitop3_b32 v25, v95, v25, s7 bitop3:0xde
    v_bitop3_b32 v25, v96, v25, s7 bitop3:0xde
    v_bitop3_b32 v25, v97, v25, s7 bitop3:0xde
    v_and_b32 v25, 1, v25
    v_cmp_ne_u32 vcc, 0, v25
    s_cbranch_vccz L_got11
    s_sleep 1
    s_branch L_rl11
L_ss12:
    buffer_store_dwordx4 v[90:93], v3, s[20:23], s79 offen sc1
    s_nop 1
    s_branch L_sd12
L_rt14:
    s_mov_b32 s70, 0
L_rl14:
    buffer_load_dwordx4 v[94:97], v3, s[20:23], s5 offen sc1
    s_add_u32 s70, s70, 1
    s_cmp_gt_u32 s70, 0x200000
    s_waitcnt vmcnt(0)
    s_cbranch_scc1 L_got14
    v_xor_b32 v25, s7, v94
    v_bitop3_b32 v25, v95, v25, s7 bitop3:0xde
    v_bitop3_b32 v25, v96, v25, s7 bitop3:0xde
    v_bitop3_b32 v25, v97, v25, s7 bitop3:0xde
    v_and_b32 v25, 1, v25
    v_cmp_ne_u32 vcc, 0, v25
    s_cbranch_vccz L_got14
    s_sleep 1
    s_branch L_rl14
L_ss15:
    buffer_store_dwordx4 v[90:93], v3, s[20:23], s79 offen sc1
    s_nop 1
    s_branch L_sd15
L_rt15:
    s_mov_b32 s70, 0
L_rl15:
    buffer_load_dwordx4 v[94:97], v3, s[20:23], s5 offen sc1
    s_add_u32 s70, s70, 1
    s_cmp_gt_u32 s70, 0x200000
    s_waitcnt vmcnt(0)
    s_cbranch_scc1 L_got15
    v_xor_b32 v25, s7, v94
    v_bitop3_b32 v25, v95, v25, s7 bitop3:0xde
    v_bitop3_b32 v25, v96, v25, s7 bitop3:0xde
    v_bitop3_b32 v25, v97, v25, s7 bitop3:0xde
    v_and_b32 v25, 1, v25
    v_cmp_ne_u32 vcc, 0, v25
    s_cbranch_vccz L_got15
    s_sleep 1
    s_branch L_rl15
.set CODE_BYTES, L_end - standalone__cross_network_dcn_v2__recsys_kernel
.section .rodata,"a"
.p2align 6
.amdhsa_kernel standalone__cross_network_dcn_v2__recsys_kernel
  .amdhsa_next_free_vgpr 256
  .amdhsa_next_free_sgpr 102
  .amdhsa_accum_offset 104
  .amdhsa_group_segment_fixed_size 0
  .amdhsa_kernarg_size 56
  .amdhsa_user_sgpr_count 2
  .amdhsa_user_sgpr_kernarg_segment_ptr 1
  .amdhsa_system_sgpr_workgroup_id_x 1
  .amdhsa_float_denorm_mode_32 3
.end_amdhsa_kernel
```
